```python
import torch

def _softmax(x, axis=-1):
    return torch.softmax(x, dim=axis)
def _gelu(x):
    return torch.nn.functional.gelu(x, approximate="tanh")
def _silu(x):
    return torch.nn.functional.silu(x)
def _sigmoid(x):
    return torch.sigmoid(x)
def _layernorm(x, axis=-1, eps=1e-5):
    m = x.mean(dim=axis, keepdim=True)
    v = x.var(dim=axis, keepdim=True, unbiased=False)
    return (x - m) / torch.sqrt(v + eps)
def _scatter_add(tgt, idx, src, axis=0):
    return tgt.clone().index_add_(axis, idx, src)
def _segment_sum(src, seg, n):
    out = torch.zeros((n,) + src.shape[1:], dtype=src.dtype)
    return out.index_add_(0, seg, src)
def _pad(x, pw):
    flat = tuple(v for pair in reversed(pw) for v in pair)
    return torch.nn.functional.pad(x, flat)

kernel_name = 'sequential_preLN__spectral_gfnet__glu_gated_geglu__prompt'

def setup_inputs():

    _w = (lambda a: (lambda t: t.to(torch.bfloat16) if t.is_floating_point() else t)(torch.as_tensor(a)))
    def _A_setup():
        B, S, D = 1, 2048, 512
        Df = D // 2 + 1
        return {
            "x": _w((lambda *s: torch.randn(*s, dtype=torch.bfloat16) * 0.05)(B, S, D)),
            "w_r": _w((lambda *s: torch.randn(*s, dtype=torch.bfloat16) * 0.4)(S, Df) * 0.02),
            "w_i": _w((lambda *s: torch.randn(*s, dtype=torch.bfloat16) * 0.4)(S, Df) * 0.02),
        }
    _A_in = _A_setup()

    def _B_setup():
        B, S, Dm, Df = 1, 2048, 512, 1376
        return {
            "x": _w((lambda *s: torch.randn(*s, dtype=torch.bfloat16) * 0.05)(B, S, Dm)),
            "w_gate": _w((lambda *s: torch.randn(*s, dtype=torch.bfloat16) * 0.4)(Dm, Df) * (Dm ** -0.5)),
            "w_up": _w((lambda *s: torch.randn(*s, dtype=torch.bfloat16) * 0.4)(Dm, Df) * (Dm ** -0.5)),
            "w_down": _w((lambda *s: torch.randn(*s, dtype=torch.bfloat16) * 0.4)(Df, Dm) * (Df ** -0.5)),
        }
    _B_in = _B_setup()

    return {
        "A_x": _A_in["x"],
        "A_w_r": _A_in["w_r"],
        "A_w_i": _A_in["w_i"],
        "B_x": _B_in["x"],
        "B_w_gate": _B_in["w_gate"],
        "B_w_up": _B_in["w_up"],
        "B_w_down": _B_in["w_down"],
    }

def reference(A_x, A_w_r, A_w_i, B_x, B_w_gate, B_w_up, B_w_down):
    def _A_ref(x, w_r, w_i):
        B, S, D = x.shape
        X = (lambda x, axes=(-2,-1): torch.fft.rfft2(x.float(), dim=axes))(x, axes=(-2, -1))
        W = w_r + 1j * w_i
        X = X * W
        y = (lambda x, s, axes=(-2,-1): torch.fft.irfft2(x, s=s, dim=axes).to(torch.bfloat16))(X, (S, D), axes=(-2, -1))
        return y

    def _B_ref(x, w_gate, w_up, w_down):
        g = torch.einsum("bsd,df->bsf", x, w_gate)
        u = torch.einsum("bsd,df->bsf", x, w_up)
        h = _gelu(g) * u
        return torch.einsum("bsf,fd->bsd", h, w_down)

    x = A_x
    h = x + _A_ref(_layernorm(x, axis=-1), A_w_r, A_w_i)
    h2 = h + _B_ref(_layernorm(h, axis=-1), B_w_gate, B_w_up, B_w_down)
    return h2
```

```asm
; @launch grid=(256,1,1) block=(512,1,1) lds=163840
.amdgcn_target "amdgcn-amd-amdhsa--gfx950"
.text
.globl sequential_preLN__spectral_gfnet__glu_gated_geglu__prompt_kernel
.p2align 8
.type sequential_preLN__spectral_gfnet__glu_gated_geglu__prompt_kernel,@function
sequential_preLN__spectral_gfnet__glu_gated_geglu__prompt_kernel:
    s_cmp_ge_u32 s2, 256
    s_cbranch_scc1 L_end
    s_load_dwordx2 s[36:37], s[0:1], 0
    s_load_dwordx2 s[4:5], s[0:1], 72
    v_lshrrev_b32 v8, 6, v0
    v_and_b32 v1, 63, v0
    v_readfirstlane_b32 s12, v8
    s_and_b32 s13, s2, 7
    s_lshr_b32 s14, s2, 3
    s_getpc_b64 s[60:61]
L_pc:
    s_lshl_b32 s62, s14, 3
    v_add_lshl_u32 v10, v8, s62, 7
    v_min_u32 v10, L_codeend-L_pc-4, v10
    v_mov_b32 v11, s61
    v_add_co_u32 v10, vcc, s60, v10
    s_nop 1
    v_addc_co_u32 v11, vcc, 0, v11, vcc
    global_load_dword v7, v[10:11], off
    s_and_b32 s60, s12, 4
    s_lshl_b32 s60, s60, 1
    s_add_u32 s61, s60, 8
    s_add_u32 s62, s60, 32
    s_load_dwordx2 s[40:41], s[0:1], s61
    s_load_dwordx2 s[44:45], s[0:1], s62
    s_mov_b32 s38, 0x200000
    s_mov_b32 s39, 0x20000
    s_mov_b32 s42, 0x101000
    s_mov_b32 s43, 0x20000
    s_mov_b32 s46, 0x158000
    s_mov_b32 s47, 0x20000
    v_lshrrev_b32 v2, 4, v1
    v_and_b32 v3, 15, v1
    s_lshl_b32 s15, s13, 5
    s_add_u32 s15, s15, s14
    s_lshl_b32 s23, s15, 10
    v_and_b32 v129, 31, v1
    v_lshlrev_b32 v129, 5, v129
    v_lshrrev_b32 v9, 5, v1
    v_lshl_add_u32 v129, v9, 4, v129
    v_lshl_add_u32 v128, v8, 18, v129
    v_bfe_u32 v9, v0, 5, 3
    v_mul_u32_u24 v9, 4112, v9
    v_min_u32 v10, 4, v3
    v_lshl_add_u32 v9, v10, 7, v9
    s_mul_i32 s60, s13, 514
    s_mul_i32 s24, s14, 32896
    s_add_u32 s24, s24, s60
    v_bfe_u32 v8, v0, 4, 4
    v_lshlrev_b32 v10, 7, v3
    v_min_u32 v10, 668, v10
    s_lshr_b32 s60, s13, 1
    s_mul_i32 s60, s60, 672
    v_add_u32 v10, s60, v10
    v_cmp_eq_u32 vcc, 15, v3
    v_mov_b32 v11, 2700
    s_mul_i32 s25, s14, 44032
    s_movk_i32 s60, 2752
    v_cndmask_b32 v10, v10, v11, vcc
    v_mad_u32_u24 v8, v8, s60, v10
    v_mov_b32 v6, 0x3b000000
    v_cvt_f32_u32 v4, v2
    v_cvt_f32_u32 v5, v3
    v_mul_f32 v4, 4.0, v4
    v_mul_f32 v37, 0x3d000000, v5
    v_mul_f32 v120, v4, v37
    v_add_f32 v121, v120, v37
    v_add_f32 v122, v121, v37
    v_add_f32 v123, v122, v37
    v_lshrrev_b32 v38, 1, v3
    v_cvt_f32_u32 v38, v38
    v_and_b32 v39, 1, v3
    s_waitcnt lgkmcnt(0)
    buffer_load_dwordx4 v[20:23], v128, s[36:39], s23 offen
    s_barrier
    buffer_load_ushort v7, v9, s[40:43], s24 offen
    buffer_load_dword v7, v8, s[44:47], s25 offen
    s_add_u32 s62, s4, 14688256
    s_addc_u32 s63, s5, 0
    s_load_dword s3, s[62:63], 0
    s_xor_b32 s61, s61, 24
    s_load_dwordx2 s[8:9], s[0:1], s61
    s_load_dwordx2 s[48:49], s[0:1], 48
    s_load_dwordx2 s[52:53], s[0:1], 56
    s_mov_b32 s6, 0x1800000
    s_mov_b32 s7, 0x20000
    s_lshl_b32 s22, s15, 14
    s_add_u32 s22, s22, 16777216
    v_mul_u32_u24 v36, 0x8000, v39
    v_lshl_or_b32 v36, v36, 16, v36
    v_cvt_f32_u32 v39, v39
    v_mul_f32 v39, 0x3e800000, v39
    v_mul_f32 v37, 0x3d800000, v38
    v_fma_f32 v124, v4, v37, v39
    v_add_f32 v125, v124, v37
    v_add_f32 v126, v125, v37
    v_add_f32 v127, v126, v37
    v_cos_f32 v60, v120
    v_sin_f32 v68, v120
    v_cos_f32 v61, v121
    v_sin_f32 v69, v121
    v_cos_f32 v62, v122
    v_sin_f32 v70, v122
    v_cos_f32 v63, v123
    v_sin_f32 v71, v123
    v_cos_f32 v64, v124
    v_sin_f32 v72, v124
    v_cos_f32 v65, v125
    v_sin_f32 v73, v125
    v_cos_f32 v66, v126
    v_sin_f32 v74, v126
    v_cos_f32 v67, v127
    v_sin_f32 v75, v127
    v_cvt_pk_bf16_f32 v44, v60, v61
    v_cvt_pk_bf16_f32 v52, -v68, -v69
    v_cvt_pk_bf16_f32 v45, v62, v63
    v_cvt_pk_bf16_f32 v53, -v70, -v71
    v_xor_b32 v46, v36, v44
    v_xor_b32 v54, v36, v52
    v_xor_b32 v47, v36, v45
    v_xor_b32 v55, v36, v53
    v_xor_b32 v48, 0x80000000, v44
    v_xor_b32 v56, 0x80000000, v52
    v_xor_b32 v49, 0x80000000, v45
    v_xor_b32 v57, 0x80000000, v53
    v_xor_b32 v50, 0x80000000, v46
    v_xor_b32 v58, 0x80000000, v54
    v_xor_b32 v51, 0x80000000, v47
    v_xor_b32 v59, 0x80000000, v55
    v_cvt_pk_bf16_f32 v76, v64, v72
    v_cvt_pk_bf16_f32 v77, v65, v73
    v_cvt_pk_bf16_f32 v78, v66, v74
    v_cvt_pk_bf16_f32 v79, v67, v75
    v_cvt_f32_u32 v36, s15
    v_mul_f32 v37, 0x3a000000, v38
    v_fmamk_f32 v36, v4, 0x43000000, v36
    v_fma_f32 v120, v36, v37, v39
    v_fmamk_f32 v121, v37, 0x43800000, v120
    v_cos_f32 v60, v120
    v_sin_f32 v68, v120
    v_cos_f32 v61, v121
    v_sin_f32 v69, v121
    v_mov_b32 v80, 0x3f80
    v_mov_b32 v81, 0xbf80
    v_mov_b32 v82, 0x3f80
    v_mov_b32 v83, 0xbf80
    v_cvt_pk_bf16_f32 v84, v60, v68
    v_cvt_pk_bf16_f32 v85, v61, v69
    v_mul_f32 v36, 0x3b000000, v5
    v_add_f32 v39, 0x3d000000, v36
    v_mul_f32 v120, v4, v36
    v_add_f32 v121, v120, v36
    v_add_f32 v122, v121, v36
    v_add_f32 v123, v122, v36
    v_mul_f32 v124, v4, v39
    v_add_f32 v125, v124, v39
    v_add_f32 v126, v125, v39
    v_add_f32 v127, v126, v39
    v_cos_f32 v60, v120
    v_sin_f32 v68, v120
    v_cos_f32 v61, v121
    v_sin_f32 v69, v121
    v_cos_f32 v62, v122
    v_sin_f32 v70, v122
    v_cos_f32 v63, v123
    v_sin_f32 v71, v123
    v_cos_f32 v64, v124
    v_sin_f32 v72, v124
    v_cos_f32 v65, v125
    v_sin_f32 v73, v125
    v_cos_f32 v66, v126
    v_sin_f32 v74, v126
    v_cos_f32 v67, v127
    v_sin_f32 v75, v127
    s_lshl_b32 s60, s12, 10
    s_add_u32 s60, s60, 122880
    v_add_u32 v133, s60, v129
    v_lshl_add_u32 v134, v1, 3, s60
    v_lshlrev_b32 v135, 8, v2
    v_lshl_add_u32 v135, v3, 2, v135
    s_mul_i32 s60, s12, 1088
    s_add_u32 s60, s60, 131068
    v_add_u32 v135, s60, v135
    s_lshl_b32 s60, s12, 8
    v_lshlrev_b32 v130, 12, v2
    v_lshl_add_u32 v130, v3, 4, v130
    v_add_u32 v130, s60, v130
    v_mul_u32_u24 v136, 2176, v2
    v_lshl_add_u32 v136, v3, 3, v136
    s_lshl_b32 s60, s12, 7
    s_add_u32 s60, s60, 131072
    v_add_u32 v136, s60, v136
    v_cmp_eq_u32 vcc, 0, v1
    v_add_u32 v132, 1024, v135
    s_nop 0
    v_cndmask_b32 v132, v135, v132, vcc
    s_waitcnt lgkmcnt(0)
    s_add_u32 s3, s3, 0x9e3779b9
    s_waitcnt vmcnt(2)
    v_lshlrev_b32 v28, 16, v20
    v_and_b32 v29, 0xffff0000, v20
    v_lshlrev_b32 v30, 16, v21
    v_and_b32 v31, 0xffff0000, v21
    v_lshlrev_b32 v32, 16, v22
    v_and_b32 v33, 0xffff0000, v22
    v_lshlrev_b32 v34, 16, v23
    v_and_b32 v35, 0xffff0000, v23
    v_pk_add_f32 v[36:37], v[28:29], v[30:31]
    v_pk_add_f32 v[38:39], v[32:33], v[34:35]
    v_pk_add_f32 v[36:37], v[36:37], v[38:39]
    v_add_f32 v36, v36, v37
    s_nop 1
    v_add_f32_dpp v36, v36, v36 quad_perm:[1,0,3,2] row_mask:0xf bank_mask:0xf
    s_nop 1
    v_add_f32_dpp v36, v36, v36 quad_perm:[2,3,0,1] row_mask:0xf bank_mask:0xf
    s_nop 1
    v_add_f32_dpp v36, v36, v36 row_half_mirror row_mask:0xf bank_mask:0xf
    s_nop 1
    v_add_f32_dpp v36, v36, v36 row_mirror row_mask:0xf bank_mask:0xf
    s_nop 1
    v_add_f32_dpp v36, v36, v36 row_bcast:15 row_mask:0xa bank_mask:0xf
    s_nop 1
    v_add_f32_dpp v36, v36, v36 row_bcast:31 row_mask:0xc bank_mask:0xf
    s_nop 0
    v_readlane_b32 s27, v36, 63
    s_nop 1
    v_mul_f32 v40, s27, v6
    v_pk_add_f32 v[38:39], v[28:29], v[40:41] op_sel_hi:[1,0] neg_lo:[0,1] neg_hi:[0,1]
    v_pk_mul_f32 v[36:37], v[38:39], v[38:39]
    v_pk_add_f32 v[38:39], v[30:31], v[40:41] op_sel_hi:[1,0] neg_lo:[0,1] neg_hi:[0,1]
    v_pk_fma_f32 v[36:37], v[38:39], v[38:39], v[36:37]
    v_pk_add_f32 v[38:39], v[32:33], v[40:41] op_sel_hi:[1,0] neg_lo:[0,1] neg_hi:[0,1]
    v_pk_fma_f32 v[36:37], v[38:39], v[38:39], v[36:37]
    v_pk_add_f32 v[38:39], v[34:35], v[40:41] op_sel_hi:[1,0] neg_lo:[0,1] neg_hi:[0,1]
    v_pk_fma_f32 v[36:37], v[38:39], v[38:39], v[36:37]
    v_add_f32 v36, v36, v37
    v_cvt_pk_bf16_f32 v40, v40, v40
    v_lshlrev_b32 v40, 16, v40
    v_add_f32_dpp v36, v36, v36 quad_perm:[1,0,3,2] row_mask:0xf bank_mask:0xf
    v_pk_add_f32 v[28:29], v[28:29], v[40:41] op_sel_hi:[1,0] neg_lo:[0,1] neg_hi:[0,1]
    s_nop 0
    v_add_f32_dpp v36, v36, v36 quad_perm:[2,3,0,1] row_mask:0xf bank_mask:0xf
    v_pk_add_f32 v[30:31], v[30:31], v[40:41] op_sel_hi:[1,0] neg_lo:[0,1] neg_hi:[0,1]
    s_nop 0
    v_add_f32_dpp v36, v36, v36 row_half_mirror row_mask:0xf bank_mask:0xf
    v_pk_add_f32 v[32:33], v[32:33], v[40:41] op_sel_hi:[1,0] neg_lo:[0,1] neg_hi:[0,1]
    s_nop 0
    v_add_f32_dpp v36, v36, v36 row_mirror row_mask:0xf bank_mask:0xf
    v_pk_add_f32 v[34:35], v[34:35], v[40:41] op_sel_hi:[1,0] neg_lo:[0,1] neg_hi:[0,1]
    s_nop 0
    v_add_f32_dpp v36, v36, v36 row_bcast:15 row_mask:0xa bank_mask:0xf
    v_cvt_pk_bf16_f32 v24, v28, v29
    s_nop 0
    v_add_f32_dpp v36, v36, v36 row_bcast:31 row_mask:0xc bank_mask:0xf
    v_cvt_pk_bf16_f32 v25, v30, v31
    v_readlane_b32 s27, v36, 63
    v_cvt_pk_bf16_f32 v26, v32, v33
    v_cvt_pk_bf16_f32 v27, v34, v35
    v_mul_f32 v36, s27, v6
    v_lshlrev_b32 v28, 16, v24
    v_cvt_pk_bf16_f32 v36, v36, v36
    v_and_b32 v29, 0xffff0000, v24
    v_lshlrev_b32 v36, 16, v36
    v_lshlrev_b32 v30, 16, v25
    v_add_f32 v36, 0x3727c5ac, v36
    v_and_b32 v31, 0xffff0000, v25
    v_cvt_pk_bf16_f32 v36, v36, v36
    v_lshlrev_b32 v32, 16, v26
    v_lshlrev_b32 v36, 16, v36
    v_and_b32 v33, 0xffff0000, v26
    v_sqrt_f32 v36, v36
    v_lshlrev_b32 v34, 16, v27
    v_cvt_pk_bf16_f32 v36, v36, v36
    v_and_b32 v35, 0xffff0000, v27
    v_lshlrev_b32 v36, 16, v36
    v_rcp_f32 v36, v36
    s_nop 0
    v_pk_mul_f32 v[28:29], v[28:29], v[36:37] op_sel_hi:[1,0]
    v_pk_mul_f32 v[30:31], v[30:31], v[36:37] op_sel_hi:[1,0]
    v_pk_mul_f32 v[32:33], v[32:33], v[36:37] op_sel_hi:[1,0]
    v_pk_mul_f32 v[34:35], v[34:35], v[36:37] op_sel_hi:[1,0]
    v_cvt_pk_bf16_f32 v24, v28, v29
    v_cvt_pk_bf16_f32 v25, v30, v31
    v_cvt_pk_bf16_f32 v26, v32, v33
    v_cvt_pk_bf16_f32 v27, v34, v35
    ds_write_b128 v133, v[24:27]
    s_waitcnt lgkmcnt(0)
    ds_read_b64_tr_b16 v[88:89], v134
    ds_read_b64_tr_b16 v[90:91], v134 offset:512
    s_waitcnt lgkmcnt(0)
    v_mfma_f32_16x16x32_bf16 v[92:95], v[88:91], v[44:47], 0
    v_mfma_f32_16x16x32_bf16 v[100:103], v[88:91], v[52:55], 0
    v_mfma_f32_16x16x32_bf16 v[96:99], v[88:91], v[48:51], 0
    v_mfma_f32_16x16x32_bf16 v[104:107], v[88:91], v[56:59], 0
    s_nop 4
    v_pk_mul_f32 v[36:37], v[92:93], v[60:61]
    v_pk_mul_f32 v[38:39], v[100:101], v[60:61]
    v_pk_fma_f32 v[36:37], v[100:101], v[68:69], v[36:37]
    v_pk_fma_f32 v[38:39], v[92:93], v[68:69], v[38:39] neg_lo:[1,0,0] neg_hi:[1,0,0]
    v_cvt_pk_bf16_f32 v108, v36, v38
    v_cvt_pk_bf16_f32 v109, v37, v39
    v_pk_mul_f32 v[36:37], v[94:95], v[62:63]
    v_pk_mul_f32 v[38:39], v[102:103], v[62:63]
    v_pk_fma_f32 v[36:37], v[102:103], v[70:71], v[36:37]
    v_pk_fma_f32 v[38:39], v[94:95], v[70:71], v[38:39] neg_lo:[1,0,0] neg_hi:[1,0,0]
    v_cvt_pk_bf16_f32 v110, v36, v38
    v_cvt_pk_bf16_f32 v111, v37, v39
    s_nop 1
    v_mfma_f32_16x16x32_bf16 v[92:95], v[76:79], v[108:111], 0
    v_mfma_f32_16x16x32_bf16 v[116:119], v[80:83], v[108:111], 0
    v_pk_mul_f32 v[40:41], v[96:97], v[64:65]
    v_pk_mul_f32 v[42:43], v[104:105], v[64:65]
    v_pk_fma_f32 v[40:41], v[104:105], v[72:73], v[40:41]
    v_pk_fma_f32 v[42:43], v[96:97], v[72:73], v[42:43] neg_lo:[1,0,0] neg_hi:[1,0,0]
    v_cvt_pk_bf16_f32 v112, v40, v42
    v_cvt_pk_bf16_f32 v113, v41, v43
    v_pk_mul_f32 v[40:41], v[98:99], v[66:67]
    v_pk_mul_f32 v[42:43], v[106:107], v[66:67]
    v_pk_fma_f32 v[40:41], v[106:107], v[74:75], v[40:41]
    v_pk_fma_f32 v[42:43], v[98:99], v[74:75], v[42:43] neg_lo:[1,0,0] neg_hi:[1,0,0]
    v_cvt_pk_bf16_f32 v114, v40, v42
    v_cvt_pk_bf16_f32 v115, v41, v43
    s_nop 1
    v_mfma_f32_16x16x32_bf16 v[96:99], v[76:79], v[112:115], 0
    v_cndmask_b32 v92, v92, v116, vcc
    v_cvt_pk_bf16_f32 v108, v92, v93
    v_cvt_pk_bf16_f32 v109, v94, v95
    ds_write_b32 v132, v108
    ds_write_b32 v135, v109 offset:128
    s_nop 2
    v_cvt_pk_bf16_f32 v112, v96, v97
    v_cvt_pk_bf16_f32 v113, v98, v99
    ds_write2_b32 v135, v112, v113 offset0:16 offset1:48
    v_mov_b32 v30, s3
    v_mov_b32 v34, s3
    s_waitcnt lgkmcnt(0)
    s_barrier
    ds_read_b64 v[88:89], v136
    ds_read_b64 v[90:91], v136 offset:1088
    s_waitcnt lgkmcnt(0)
    v_swap_b32 v89, v90
    s_nop 1
    v_mfma_f32_16x16x16_bf16 v[92:95], v[84:85], v[88:89], 0
    v_mfma_f32_16x16x16_bf16 v[96:99], v[84:85], v[90:91], 0
    s_nop 6
    v_cvt_pk_bf16_f32 v28, v92, v93
    v_cvt_pk_bf16_f32 v29, v96, v97
    buffer_store_dwordx4 v[28:31], v130, s[4:7], s22 offen offset:0 sc1
    v_cvt_pk_bf16_f32 v32, v94, v95
    v_cvt_pk_bf16_f32 v33, v98, v99
    buffer_store_dwordx4 v[32:35], v130, s[4:7], s22 offen offset:2048 sc1
    v_lshrrev_b32 v243, 1, v0
    v_mul_u32_u24 v243, 4112, v243
    v_and_b32 v9, 1, v0
    v_lshl_add_u32 v243, v9, 3, v243
    s_mul_i32 s26, s13, 514
    s_lshl_b32 s27, s14, 4
    s_add_u32 s27, s27, s26
    s_add_u32 s27, s27, 2
    s_and_b32 s28, s27, 2
    s_and_b32 s27, s27, 0xfffffffc
    s_barrier
    buffer_load_dwordx3 v[244:246], v243, s[40:43], s27 offen
    s_mov_b32 s10, 0x101000
    s_mov_b32 s11, 0x20000
    v_lshlrev_b32 v12, 4, v0
    v_lshrrev_b32 v9, 2, v0
    v_and_b32 v10, 3, v0
    v_and_b32 v84, 0x40, v9
    v_and_b32 v11, 3, v9
    v_lshl_add_u32 v84, v11, 4, v84
    v_bfe_u32 v11, v9, 2, 4
    v_add_lshl_u32 v84, v84, v11, 14
    v_lshl_add_u32 v84, v10, 4, v84
    s_lshl_b32 s23, s13, 11
    s_lshl_b32 s60, s14, 6
    s_add_u32 s23, s23, s60
    s_add_u32 s23, s23, 16777216
    s_add_u32 s25, s23, 2097152
    v_mul_u32_u24 v85, 2080, v10
    v_lshl_add_u32 v85, v9, 2, v85
    v_add_u32 v85, 147456, v85
    s_lshr_b32 s60, s12, 1
    s_lshl_b32 s60, s60, 5
    s_add_u32 s60, s60, 147456
    v_add_u32 v86, s60, v12
    v_mov_b32 v52, 0
    v_mov_b32 v56, 0
    v_mov_b32 v53, 0
    v_mov_b32 v57, 0
    v_mov_b32 v54, 0
    v_mov_b32 v58, 0
    v_mov_b32 v55, 0
    v_mov_b32 v59, 0
    v_lshl_add_u32 v87, v2, 6, v3
    v_mul_f32 v9, 0x3d800000, v5
    v_add_f32 v10, 0x00000000, v4
    v_mul_f32 v72, v10, v9
    v_add_f32 v10, 0x3f800000, v4
    v_mul_f32 v73, v10, v9
    v_add_f32 v10, 0x40000000, v4
    v_mul_f32 v74, v10, v9
    v_add_f32 v10, 0x40400000, v4
    v_mul_f32 v75, v10, v9
    v_cos_f32 v44, v72
    v_sin_f32 v48, v72
    v_cos_f32 v45, v73
    v_sin_f32 v49, v73
    v_cos_f32 v46, v74
    v_sin_f32 v50, v74
    v_cos_f32 v47, v75
    v_sin_f32 v51, v75
    v_cvt_pk_bf16_f32 v28, v44, v48
    v_cvt_pk_bf16_f32 v32, -v48, v44
    v_cvt_pk_bf16_f32 v36, v44, -v48
    v_cvt_pk_bf16_f32 v40, v48, v44
    v_cvt_pk_bf16_f32 v29, v45, v49
    v_cvt_pk_bf16_f32 v33, -v49, v45
    v_cvt_pk_bf16_f32 v37, v45, -v49
    v_cvt_pk_bf16_f32 v41, v49, v45
    v_cvt_pk_bf16_f32 v30, v46, v50
    v_cvt_pk_bf16_f32 v34, -v50, v46
    v_cvt_pk_bf16_f32 v38, v46, -v50
    v_cvt_pk_bf16_f32 v42, v50, v46
    v_cvt_pk_bf16_f32 v31, v47, v51
    v_cvt_pk_bf16_f32 v35, -v51, v47
    v_cvt_pk_bf16_f32 v39, v47, -v51
    v_cvt_pk_bf16_f32 v43, v51, v47
    v_mul_f32 v72, 0x3d800000, v72
    v_mul_f32 v73, 0x3d800000, v73
    v_mul_f32 v74, 0x3d800000, v74
    v_mul_f32 v75, 0x3d800000, v75
    v_cos_f32 v44, v72
    v_sin_f32 v48, v72
    v_cos_f32 v45, v73
    v_sin_f32 v49, v73
    v_cos_f32 v46, v74
    v_sin_f32 v50, v74
    v_cos_f32 v47, v75
    v_sin_f32 v51, v75
    v_mul_u32_u24 v87, 24, v87
    v_lshl_add_u32 v87, v2, 2, v87
    s_lshl_b32 s60, s12, 1
    s_add_u32 s60, s60, s28
    s_add_u32 s60, s60, 98304
    v_add_u32 v87, s60, v87
    v_lshrrev_b32 v9, 1, v0
    v_mul_u32_u24 v9, 24, v9
    v_lshrrev_b32 v10, 7, v0
    v_lshl_add_u32 v9, v10, 2, v9
    v_and_b32 v10, 1, v0
    v_lshl_add_u32 v9, v10, 3, v9
    s_lshr_b32 s60, s12, 2
    s_mul_i32 s60, s60, 12288
    s_add_u32 s61, s60, 98304
    s_sub_u32 s60, 110592, s60
    v_add_u32 v10, s60, v9
    v_add_u32 v9, s61, v9
    s_waitcnt vmcnt(1)
    buffer_load_dwordx4 v[76:79], v84, s[4:7], s23 offen sc1
    buffer_load_dwordx4 v[80:83], v84, s[4:7], s25 offen sc1
    s_barrier
    buffer_load_dwordx3 v[248:250], v243, s[8:11], s27 offen
    v_lshlrev_b32 v15, 4, v1
    s_mov_b32 s50, 0x158000
    s_mov_b32 s51, 0x20000
    s_mov_b32 s54, 0x200000
    s_mov_b32 s55, 0x20000
    s_mov_b32 s58, 0x560000
    s_mov_b32 s59, 0x20000
    s_add_u32 s56, s4, 8388608
    s_addc_u32 s57, s5, 0
    v_mov_b32 v252, -1
    v_mov_b32 v253, -1
    v_mov_b32 v254, -1
    v_mov_b32 v255, -1
    v_lshrrev_b32 v8, 3, v0
    v_lshlrev_b32 v13, 9, v8
    v_and_b32 v8, 7, v0
    v_lshl_add_u32 v13, v8, 4, v13
    s_lshr_b32 s21, s15, 2
    s_lshl_b32 s21, s21, 15
    s_and_b32 s60, s15, 3
    s_lshl_b32 s60, s60, 7
    s_add_u32 s21, s21, s60
    s_add_u32 s21, s21, 6291456
    s_lshl_b32 s24, s2, 14
    s_add_u32 s24, s24, 20971520
    s_and_b32 s16, s13, 1
    s_lshl_b32 s16, s16, 2
    s_and_b32 s60, s14, 3
    s_add_u32 s16, s16, s60
    s_lshl_b32 s16, s16, 3
    s_add_u32 s16, s16, s12
    s_lshr_b32 s17, s13, 1
    s_add_u32 s61, s17, 28
    s_mul_i32 s17, s17, 7
    s_lshr_b32 s18, s14, 2
    s_add_u32 s17, s17, s18
    s_cmp_eq_u32 s18, 7
    s_cselect_b32 s17, s61, s17
    s_and_b32 s60, s12, 3
    s_mul_i32 s19, s60, 88064
    s_mul_i32 s61, s17, 96
    s_add_u32 s19, s19, s61
    s_mul_i32 s20, s60, 3072
    s_lshr_b32 s60, s12, 2
    s_mul_i32 s60, s60, 49152
    s_add_u32 s20, s20, s60
    s_and_b32 s61, s12, 4
    v_add_u32 v8, 0, v1
    v_mul_u32_u24 v7, 171, v8
    v_lshrrev_b32 v7, 10, v7
    v_xor_b32 v11, s61, v7
    v_mul_u32_u24 v17, 2752, v11
    v_mul_u32_u24 v7, 96, v7
    v_sub_u32 v17, v17, v7
    v_add_u32 v17, v17, v15
    v_add_u32 v8, 64, v1
    v_mul_u32_u24 v7, 171, v8
    v_lshrrev_b32 v7, 10, v7
    v_xor_b32 v11, s61, v7
    v_mul_u32_u24 v18, 2752, v11
    v_mul_u32_u24 v7, 96, v7
    v_sub_u32 v18, v18, v7
    v_add_u32 v18, v18, v15
    v_add_u32 v8, 128, v1
    v_mul_u32_u24 v7, 171, v8
    v_lshrrev_b32 v7, 10, v7
    v_xor_b32 v11, s61, v7
    v_mul_u32_u24 v19, 2752, v11
    v_mul_u32_u24 v7, 96, v7
    v_sub_u32 v19, v19, v7
    v_add_u32 v19, v19, v15
    s_mul_i32 s60, s17, 196608
    s_lshl_b32 s61, s16, 10
    s_add_u32 s60, s60, s61
    v_add_u32 v16, s60, v15
    s_waitcnt vmcnt(3)
    ds_write2_b32 v9, v244, v245 offset0:0 offset1:1
    ds_write_b32 v9, v246 offset:8
    s_waitcnt vmcnt(1)
    v_cmp_ne_u32 vcc, s3, v78
    v_cmp_ne_u32 s[62:63], s3, v82
    s_nop 0
    s_or_b64 vcc, vcc, s[62:63]
    s_cbranch_vccnz Lpu_r
Lpu_ok:
    ds_write2st64_b32 v85, v76, v77 offset0:0 offset1:4
    ds_write2st64_b32 v85, v80, v81 offset0:2 offset1:6
    s_waitcnt lgkmcnt(0)
    s_barrier
    ds_read_b128 v[24:27], v86
    s_waitcnt lgkmcnt(0)
    v_mfma_f32_16x16x32_bf16 v[60:63], v[24:27], v[28:31], 0
    v_mfma_f32_16x16x32_bf16 v[64:67], v[24:27], v[32:35], 0
    s_waitcnt vmcnt(0)
    ds_write2_b32 v10, v248, v249 offset0:0 offset1:1
    ds_write_b32 v10, v250 offset:8
    buffer_store_dwordx4 v[252:255], v13, s[4:7], s21 offen sc1
    s_nop 2
    v_pk_mul_f32 v[68:69], v[60:61], v[44:45]
    v_pk_mul_f32 v[70:71], v[64:65], v[44:45]
    v_pk_fma_f32 v[68:69], v[64:65], v[48:49], v[68:69]
    v_pk_fma_f32 v[70:71], v[60:61], v[48:49], v[70:71] neg_lo:[1,0,0] neg_hi:[1,0,0]
    v_cvt_pk_bf16_f32 v24, v68, v70
    v_cvt_pk_bf16_f32 v25, v69, v71
    v_pk_mul_f32 v[68:69], v[62:63], v[46:47]
    v_pk_mul_f32 v[70:71], v[66:67], v[46:47]
    v_pk_fma_f32 v[68:69], v[66:67], v[50:51], v[68:69]
    v_pk_fma_f32 v[70:71], v[62:63], v[50:51], v[70:71] neg_lo:[1,0,0] neg_hi:[1,0,0]
    v_cvt_pk_bf16_f32 v26, v68, v70
    v_cvt_pk_bf16_f32 v27, v69, v71
    s_waitcnt lgkmcnt(0)
    s_barrier
    ds_read_u16_d16_hi v52, v87 offset:0
    ds_read_u16_d16_hi v56, v87 offset:12288
    ds_read_u16_d16_hi v53, v87 offset:384
    ds_read_u16_d16_hi v57, v87 offset:12672
    ds_read_u16_d16_hi v54, v87 offset:768
    ds_read_u16_d16_hi v58, v87 offset:13056
    ds_read_u16_d16_hi v55, v87 offset:1152
    ds_read_u16_d16_hi v59, v87 offset:13440
    v_mfma_f32_16x16x32_bf16 v[60:63], v[28:31], v[24:27], 0
    v_mfma_f32_16x16x32_bf16 v[64:67], v[32:35], v[24:27], 0
    s_add_u32 m0, s20, 0
    s_add_u32 s32, s19, 0
    buffer_load_dwordx4 v17, s[44:47], s32 offen offset:0 lds
    s_waitcnt lgkmcnt(0)
    s_nop 2
    v_pk_mul_f32 v[68:69], v[60:61], v[52:53]
    v_pk_mul_f32 v[70:71], v[64:65], v[52:53]
    v_pk_fma_f32 v[68:69], v[64:65], v[56:57], v[68:69] neg_lo:[1,0,0] neg_hi:[1,0,0]
    v_pk_fma_f32 v[70:71], v[60:61], v[56:57], v[70:71]
    v_cvt_pk_bf16_f32 v24, v68, v70
    v_cvt_pk_bf16_f32 v25, v69, v71
    v_pk_mul_f32 v[68:69], v[62:63], v[54:55]
    v_pk_mul_f32 v[70:71], v[66:67], v[54:55]
    v_pk_fma_f32 v[68:69], v[66:67], v[58:59], v[68:69] neg_lo:[1,0,0] neg_hi:[1,0,0]
    v_pk_fma_f32 v[70:71], v[62:63], v[58:59], v[70:71]
    v_cvt_pk_bf16_f32 v26, v68, v70
    v_cvt_pk_bf16_f32 v27, v69, v71
    s_nop 1
    v_mfma_f32_16x16x32_bf16 v[60:63], v[24:27], v[36:39], 0
    v_mfma_f32_16x16x32_bf16 v[64:67], v[24:27], v[40:43], 0
    s_add_u32 m0, s20, 0
    s_add_u32 s32, s19, 0
    buffer_load_dwordx4 v18, s[44:47], s32 offen offset:1024 lds
    s_nop 3
    v_pk_mul_f32 v[68:69], v[60:61], v[44:45]
    v_pk_mul_f32 v[70:71], v[64:65], v[44:45]
    v_pk_fma_f32 v[68:69], v[64:65], v[48:49], v[68:69] neg_lo:[1,0,0] neg_hi:[1,0,0]
    v_pk_fma_f32 v[70:71], v[60:61], v[48:49], v[70:71]
    v_cvt_pk_bf16_f32 v24, v68, v70
    v_cvt_pk_bf16_f32 v25, v69, v71
    v_pk_mul_f32 v[68:69], v[62:63], v[46:47]
    v_pk_mul_f32 v[70:71], v[66:67], v[46:47]
    v_pk_fma_f32 v[68:69], v[66:67], v[50:51], v[68:69] neg_lo:[1,0,0] neg_hi:[1,0,0]
    v_pk_fma_f32 v[70:71], v[62:63], v[50:51], v[70:71]
    v_cvt_pk_bf16_f32 v26, v68, v70
    v_cvt_pk_bf16_f32 v27, v69, v71
    s_nop 1
    v_mfma_f32_16x16x32_bf16 v[60:63], v[36:39], v[24:27], 0
    v_mfma_f32_16x16x32_bf16 v[64:67], v[40:43], v[24:27], 0
    s_nop 7
    v_cvt_pk_bf16_f32 v24, v60, v64
    v_cvt_pk_bf16_f32 v25, v61, v65
    v_cvt_pk_bf16_f32 v26, v62, v66
    v_cvt_pk_bf16_f32 v27, v63, v67
    ds_write_b128 v86, v[24:27]
    s_waitcnt vmcnt(2) lgkmcnt(0)
    s_barrier
    ds_read2st64_b32 v[76:77], v85 offset0:0 offset1:4
    ds_read2st64_b32 v[80:81], v85 offset0:2 offset1:6
    s_add_u32 s60, s24, 8192
    s_waitcnt lgkmcnt(1)
    buffer_store_dwordx4 v[76:79], v12, s[4:7], s24 offen sc1
    s_waitcnt lgkmcnt(0)
    buffer_store_dwordx4 v[80:83], v12, s[4:7], s60 offen sc1
    s_barrier
    s_add_u32 m0, s20, 0
    s_add_u32 s32, s19, 0
    buffer_load_dwordx4 v19, s[44:47], s32 offen offset:2048 lds
    s_add_u32 m0, s20, 12288
    s_add_u32 s32, s19, 352256
    buffer_load_dwordx4 v17, s[44:47], s32 offen offset:0 lds
    s_add_u32 m0, s20, 12288
    s_add_u32 s32, s19, 352256
    buffer_load_dwordx4 v18, s[44:47], s32 offen offset:1024 lds
    s_add_u32 m0, s20, 12288
    s_add_u32 s32, s19, 352256
    buffer_load_dwordx4 v19, s[44:47], s32 offen offset:2048 lds
    v_lshrrev_b32 v10, 1, v3
    v_cvt_f32_u32 v10, v10
    v_and_b32 v11, 1, v3
    v_cvt_f32_u32 v11, v11
    v_mul_f32 v11, 0xbe800000, v11
    v_cvt_f32_u32 v8, s15
    v_fmamk_f32 v8, v10, 0x43800000, v8
    v_mul_f32 v8, 0x3a000000, v8
    v_mul_f32 v9, 0.5, v4
    v_fma_f32 v56, v9, v8, v11
    v_add_f32 v57, v56, v8
    v_mul_f32 v8, 0x3d800000, v5
    v_mul_f32 v58, v9, v8
    v_add_f32 v59, v58, v8
    v_mul_f32 v8, 0x3d000000, v5
    v_add_f32 v10, 0x00000000, v4
    v_mul_f32 v60, v10, v8
    v_add_f32 v10, 0x3f800000, v4
    v_mul_f32 v61, v10, v8
    v_add_f32 v10, 0x40000000, v4
    v_mul_f32 v62, v10, v8
    v_add_f32 v10, 0x40400000, v4
    v_mul_f32 v63, v10, v8
    v_cos_f32 v40, v56
    v_sin_f32 v48, v56
    v_cos_f32 v41, v57
    v_sin_f32 v49, v57
    v_cos_f32 v42, v58
    v_sin_f32 v50, v58
    v_cos_f32 v43, v59
    v_sin_f32 v51, v59
    v_cos_f32 v44, v60
    v_sin_f32 v52, v60
    v_cos_f32 v45, v61
    v_sin_f32 v53, v61
    v_cos_f32 v46, v62
    v_sin_f32 v54, v62
    v_cos_f32 v47, v63
    v_sin_f32 v55, v63
    v_lshlrev_b32 v144, 15, v2
    v_lshrrev_b32 v9, 2, v3
    v_lshl_add_u32 v144, v9, 17, v144
    v_and_b32 v9, 3, v3
    v_lshl_add_u32 v144, v9, 4, v144
    s_lshl_b32 s23, s12, 19
    s_and_b32 s60, s15, 0xc0
    s_and_b32 s61, s15, 15
    s_lshl_b32 s61, s61, 2
    s_add_u32 s60, s60, s61
    s_bfe_u32 s61, s15, 0x20004
    s_add_u32 s60, s60, s61
    s_lshl_b32 s60, s60, 6
    s_add_u32 s23, s23, s60
    s_add_u32 s23, s23, 20971520
    s_add_u32 s25, s23, 16384
    v_cvt_pk_bf16_f32 v112, v40, -v48
    v_cvt_pk_bf16_f32 v114, v42, -v50
    v_cvt_pk_bf16_f32 v116, v50, v42
    v_cvt_pk_bf16_f32 v113, v41, -v49
    v_cvt_pk_bf16_f32 v115, v43, -v51
    v_cvt_pk_bf16_f32 v117, v51, v43
    v_cvt_pk_bf16_f32 v24, v44, -v52
    v_cvt_pk_bf16_f32 v25, v45, -v53
    v_cvt_pk_bf16_f32 v26, v46, -v54
    v_cvt_pk_bf16_f32 v27, v47, -v55
    v_and_b32 v11, 1, v3
    v_mul_u32_u24 v11, 0x8000, v11
    v_lshl_or_b32 v11, v11, 16, v11
    v_xor_b32 v32, v11, v24
    v_xor_b32 v33, v11, v25
    v_xor_b32 v34, v11, v26
    v_xor_b32 v35, v11, v27
    v_mov_b32 v28, v24
    v_xor_b32 v29, 0x80008000, v25
    v_mov_b32 v30, v26
    v_xor_b32 v31, 0x80008000, v27
    v_mov_b32 v36, v32
    v_xor_b32 v37, 0x80008000, v33
    v_mov_b32 v38, v34
    v_xor_b32 v39, 0x80008000, v35
    s_waitcnt vmcnt(4)
    buffer_load_dwordx4 v[88:91], v144, s[4:7], s23 offen sc1
    buffer_load_dwordx4 v[92:95], v144, s[4:7], s25 offen sc1
    v_mul_f32 v8, 0x3b000000, v5
    v_add_f32 v10, 0x00000000, v4
    v_mul_f32 v56, v10, v8
    v_add_f32 v10, 0x3f800000, v4
    v_mul_f32 v57, v10, v8
    v_add_f32 v10, 0x40000000, v4
    v_mul_f32 v58, v10, v8
    v_add_f32 v10, 0x40400000, v4
    v_mul_f32 v59, v10, v8
    v_add_f32 v10, 0x41800000, v4
    v_mul_f32 v60, v10, v8
    v_add_f32 v10, 0x41880000, v4
    v_mul_f32 v61, v10, v8
    v_add_f32 v10, 0x41900000, v4
    v_mul_f32 v62, v10, v8
    v_add_f32 v10, 0x41980000, v4
    v_mul_f32 v63, v10, v8
    v_cos_f32 v40, v56
    v_sin_f32 v48, v56
    v_cos_f32 v41, v57
    v_sin_f32 v49, v57
    v_cos_f32 v42, v58
    v_sin_f32 v50, v58
    v_cos_f32 v43, v59
    v_sin_f32 v51, v59
    v_cos_f32 v44, v60
    v_sin_f32 v52, v60
    v_cos_f32 v45, v61
    v_sin_f32 v53, v61
    v_cos_f32 v46, v62
    v_sin_f32 v54, v62
    v_cos_f32 v47, v63
    v_sin_f32 v55, v63
    v_mov_b32 v10, 0x36000000
    v_pk_mul_f32 v[40:41], v[40:41], v[10:11] op_sel_hi:[1,0]
    v_pk_mul_f32 v[48:49], v[48:49], v[10:11] op_sel_hi:[1,0]
    v_pk_mul_f32 v[42:43], v[42:43], v[10:11] op_sel_hi:[1,0]
    v_pk_mul_f32 v[50:51], v[50:51], v[10:11] op_sel_hi:[1,0]
    v_pk_mul_f32 v[44:45], v[44:45], v[10:11] op_sel_hi:[1,0]
    v_pk_mul_f32 v[52:53], v[52:53], v[10:11] op_sel_hi:[1,0]
    v_pk_mul_f32 v[46:47], v[46:47], v[10:11] op_sel_hi:[1,0]
    v_pk_mul_f32 v[54:55], v[54:55], v[10:11] op_sel_hi:[1,0]
    v_lshlrev_b32 v145, 11, v2
    v_lshl_add_u32 v145, v3, 3, v145
    s_lshl_b32 s60, s12, 7
    s_add_u32 s60, s60, 122880
    v_add_u32 v145, s60, v145
    v_lshlrev_b32 v146, 8, v2
    v_lshl_add_u32 v146, v3, 2, v146
    s_lshl_b32 s60, s12, 10
    s_add_u32 s60, s60, 122876
    v_add_u32 v146, s60, v146
    v_cmp_eq_u32 vcc, 0, v1
    v_add_u32 v147, 1024, v146
    s_nop 0
    v_cndmask_b32 v147, v146, v147, vcc
    v_lshlrev_b32 v148, 8, v3
    v_lshrrev_b32 v9, 1, v2
    v_lshl_add_u32 v148, v9, 7, v148
    v_and_b32 v9, 1, v2
    v_lshl_add_u32 v148, v9, 12, v148
    v_xor_b32 v9, s12, v3
    v_and_b32 v9, 7, v9
    v_lshl_add_u32 v148, v9, 4, v148
    v_add_u32 v148, 131072, v148
    v_and_b32 v149, 0x70, v0
    v_xor_b32 v149, v149, v12
    v_add_u32 v149, 131072, v149
    v_lshlrev_b32 v96, 16, v20
    v_and_b32 v97, 0xffff0000, v20
    v_lshlrev_b32 v98, 16, v21
    v_and_b32 v99, 0xffff0000, v21
    v_lshlrev_b32 v100, 16, v22
    v_and_b32 v101, 0xffff0000, v22
    v_lshlrev_b32 v102, 16, v23
    v_and_b32 v103, 0xffff0000, v23
    s_waitcnt vmcnt(0)
    v_cmp_ne_u32 vcc, s3, v90
    v_cmp_ne_u32 s[62:63], s3, v94
    s_nop 0
    s_or_b64 vcc, vcc, s[62:63]
    s_cbranch_vccnz Lpv_r
Lpv_ok:
    v_swap_b32 v89, v92
    s_nop 1
    v_mfma_f32_16x16x16_bf16 v[136:139], v[112:113], v[88:89], 0
    v_mfma_f32_16x16x16_bf16 v[140:143], v[112:113], v[92:93], 0
    v_cmp_ne_u32 vcc, 0, v1
    v_mov_b32 v10, 0x35800000
    s_nop 4
    v_cvt_pk_bf16_f32 v64, v136, v137
    v_cvt_pk_bf16_f32 v65, v140, v141
    ds_write_b64 v145, v[64:65] offset:0
    v_cvt_pk_bf16_f32 v66, v138, v139
    v_cvt_pk_bf16_f32 v67, v142, v143
    ds_write_b64 v145, v[66:67] offset:1024
    s_waitcnt lgkmcnt(0)
    s_barrier
    ds_read2_b32 v[90:91], v146 offset0:16 offset1:48
    ds_read_b32 v88, v147
    ds_read_b32 v89, v146 offset:128
    s_add_u32 m0, s20, 24576
    s_add_u32 s32, s19, 704512
    buffer_load_dwordx4 v17, s[44:47], s32 offen offset:0 lds
    s_waitcnt lgkmcnt(2)
    v_mfma_f32_16x16x16_bf16 v[124:127], v[90:91], v[114:115], 0
    v_mfma_f32_16x16x16_bf16 v[132:135], v[90:91], v[116:117], 0
    s_waitcnt lgkmcnt(0)
    v_readlane_b32 s26, v88, 0
    v_cndmask_b32 v88, 0, v88, vcc
    s_lshl_b32 s26, s26, 16
    s_nop 0
    v_mfma_f32_16x16x16_bf16 v[120:123], v[88:89], v[114:115], 0
    v_mfma_f32_16x16x16_bf16 v[128:131], v[88:89], v[116:117], 0
    v_mul_f32 v136, s26, v10
    v_sub_f32 v137, 0, v136
    v_pk_mov_b32 v[138:139], v[136:137], v[136:137] op_sel:[0,1]
    v_pk_mov_b32 v[140:141], v[136:137], v[136:137] op_sel:[0,1]
    v_pk_mov_b32 v[142:143], v[136:137], v[136:137] op_sel:[0,1]
    v_pk_mul_f32 v[108:109], v[124:125], v[44:45]
    v_pk_mul_f32 v[110:111], v[132:133], v[44:45]
    v_pk_fma_f32 v[108:109], v[132:133], v[52:53], v[108:109] neg_lo:[1,0,0] neg_hi:[1,0,0]
    v_pk_fma_f32 v[110:111], v[124:125], v[52:53], v[110:111]
    v_cvt_pk_bf16_f32 v68, v108, v110
    v_cvt_pk_bf16_f32 v69, v109, v111
    v_pk_mul_f32 v[108:109], v[126:127], v[46:47]
    v_pk_mul_f32 v[110:111], v[134:135], v[46:47]
    v_pk_fma_f32 v[108:109], v[134:135], v[54:55], v[108:109] neg_lo:[1,0,0] neg_hi:[1,0,0]
    v_pk_fma_f32 v[110:111], v[126:127], v[54:55], v[110:111]
    v_cvt_pk_bf16_f32 v70, v108, v110
    v_cvt_pk_bf16_f32 v71, v109, v111
    s_nop 1
    v_mfma_f32_16x16x32_bf16 v[136:139], v[68:71], v[32:35], v[136:139]
    v_mfma_f32_16x16x32_bf16 v[140:143], v[68:71], v[36:39], v[140:143]
    s_add_u32 m0, s20, 24576
    s_add_u32 s32, s19, 704512
    buffer_load_dwordx4 v18, s[44:47], s32 offen offset:1024 lds
    v_pk_mul_f32 v[104:105], v[120:121], v[40:41]
    v_pk_mul_f32 v[106:107], v[128:129], v[40:41]
    v_pk_fma_f32 v[104:105], v[128:129], v[48:49], v[104:105] neg_lo:[1,0,0] neg_hi:[1,0,0]
    v_pk_fma_f32 v[106:107], v[120:121], v[48:49], v[106:107]
    v_cvt_pk_bf16_f32 v64, v104, v106
    v_cvt_pk_bf16_f32 v65, v105, v107
    v_pk_mul_f32 v[104:105], v[122:123], v[42:43]
    v_pk_mul_f32 v[106:107], v[130:131], v[42:43]
    v_pk_fma_f32 v[104:105], v[130:131], v[50:51], v[104:105] neg_lo:[1,0,0] neg_hi:[1,0,0]
    v_pk_fma_f32 v[106:107], v[122:123], v[50:51], v[106:107]
    v_cvt_pk_bf16_f32 v66, v104, v106
    v_cvt_pk_bf16_f32 v67, v105, v107
    s_nop 1
    v_mfma_f32_16x16x32_bf16 v[136:139], v[64:67], v[24:27], v[136:139]
    v_mfma_f32_16x16x32_bf16 v[140:143], v[64:67], v[28:31], v[140:143]
    s_add_u32 m0, s20, 24576
    s_add_u32 s32, s19, 704512
    buffer_load_dwordx4 v19, s[44:47], s32 offen offset:2048 lds
    s_nop 3
    v_cvt_pk_bf16_f32 v64, v136, v137
    v_cvt_pk_bf16_f32 v65, v138, v139
    v_cvt_pk_bf16_f32 v66, v140, v141
    v_cvt_pk_bf16_f32 v67, v142, v143
    s_nop 0
    v_permlane16_swap_b32 v64, v66
    v_permlane16_swap_b32 v65, v67
    v_lshlrev_b32 v120, 16, v64
    v_and_b32 v121, 0xffff0000, v64
    v_lshlrev_b32 v122, 16, v65
    v_and_b32 v123, 0xffff0000, v65
    v_lshlrev_b32 v124, 16, v66
    v_and_b32 v125, 0xffff0000, v66
    v_lshlrev_b32 v126, 16, v67
    v_and_b32 v127, 0xffff0000, v67
    v_pk_add_f32 v[96:97], v[96:97], v[120:121]
    v_pk_add_f32 v[98:99], v[98:99], v[122:123]
    v_pk_add_f32 v[100:101], v[100:101], v[124:125]
    v_pk_add_f32 v[102:103], v[102:103], v[126:127]
    v_cvt_pk_bf16_f32 v68, v96, v97
    v_cvt_pk_bf16_f32 v69, v98, v99
    v_cvt_pk_bf16_f32 v70, v100, v101
    v_cvt_pk_bf16_f32 v71, v102, v103
    s_add_u32 m0, s20, 36864
    s_add_u32 s32, s19, 1056768
    buffer_load_dwordx4 v17, s[44:47], s32 offen offset:0 lds
    ds_write_b128 v148, v[68:71] offset:8192
    v_lshlrev_b32 v96, 16, v68
    v_and_b32 v97, 0xffff0000, v68
    v_lshlrev_b32 v98, 16, v69
    v_and_b32 v99, 0xffff0000, v69
    v_lshlrev_b32 v100, 16, v70
    v_and_b32 v101, 0xffff0000, v70
    v_lshlrev_b32 v102, 16, v71
    v_and_b32 v103, 0xffff0000, v71
    v_pk_add_f32 v[104:105], v[96:97], v[98:99]
    v_pk_add_f32 v[106:107], v[100:101], v[102:103]
    v_pk_add_f32 v[104:105], v[104:105], v[106:107]
    v_add_f32 v104, v104, v105
    s_nop 1
    v_add_f32_dpp v104, v104, v104 quad_perm:[1,0,3,2] row_mask:0xf bank_mask:0xf
    s_nop 1
    v_add_f32_dpp v104, v104, v104 quad_perm:[2,3,0,1] row_mask:0xf bank_mask:0xf
    s_add_u32 m0, s20, 36864
    s_add_u32 s32, s19, 1056768
    buffer_load_dwordx4 v18, s[44:47], s32 offen offset:1024 lds
    v_add_f32_dpp v104, v104, v104 row_half_mirror row_mask:0xf bank_mask:0xf
    s_nop 1
    v_add_f32_dpp v104, v104, v104 row_mirror row_mask:0xf bank_mask:0xf
    s_nop 1
    v_add_f32_dpp v104, v104, v104 row_bcast:15 row_mask:0xa bank_mask:0xf
    s_nop 1
    v_add_f32_dpp v104, v104, v104 row_bcast:31 row_mask:0xc bank_mask:0xf
    s_nop 0
    v_readlane_b32 s26, v104, 63
    s_nop 1
    v_mul_f32 v108, s26, v6
    v_pk_add_f32 v[106:107], v[96:97], v[108:109] op_sel_hi:[1,0] neg_lo:[0,1] neg_hi:[0,1]
    v_pk_mul_f32 v[104:105], v[106:107], v[106:107]
    v_pk_add_f32 v[106:107], v[98:99], v[108:109] op_sel_hi:[1,0] neg_lo:[0,1] neg_hi:[0,1]
    v_pk_fma_f32 v[104:105], v[106:107], v[106:107], v[104:105]
    v_pk_add_f32 v[106:107], v[100:101], v[108:109] op_sel_hi:[1,0] neg_lo:[0,1] neg_hi:[0,1]
    v_pk_fma_f32 v[104:105], v[106:107], v[106:107], v[104:105]
    v_pk_add_f32 v[106:107], v[102:103], v[108:109] op_sel_hi:[1,0] neg_lo:[0,1] neg_hi:[0,1]
    v_pk_fma_f32 v[104:105], v[106:107], v[106:107], v[104:105]
    v_add_f32 v104, v104, v105
    v_cvt_pk_bf16_f32 v108, v108, v108
    v_lshlrev_b32 v108, 16, v108
    v_add_f32_dpp v104, v104, v104 quad_perm:[1,0,3,2] row_mask:0xf bank_mask:0xf
    v_pk_add_f32 v[96:97], v[96:97], v[108:109] op_sel_hi:[1,0] neg_lo:[0,1] neg_hi:[0,1]
    s_nop 0
    v_add_f32_dpp v104, v104, v104 quad_perm:[2,3,0,1] row_mask:0xf bank_mask:0xf
    v_pk_add_f32 v[98:99], v[98:99], v[108:109] op_sel_hi:[1,0] neg_lo:[0,1] neg_hi:[0,1]
    s_nop 0
    v_add_f32_dpp v104, v104, v104 row_half_mirror row_mask:0xf bank_mask:0xf
    v_pk_add_f32 v[100:101], v[100:101], v[108:109] op_sel_hi:[1,0] neg_lo:[0,1] neg_hi:[0,1]
    s_nop 0
    v_add_f32_dpp v104, v104, v104 row_mirror row_mask:0xf bank_mask:0xf
    v_pk_add_f32 v[102:103], v[102:103], v[108:109] op_sel_hi:[1,0] neg_lo:[0,1] neg_hi:[0,1]
    s_nop 0
    v_add_f32_dpp v104, v104, v104 row_bcast:15 row_mask:0xa bank_mask:0xf
    v_cvt_pk_bf16_f32 v64, v96, v97
    s_nop 0
    v_add_f32_dpp v104, v104, v104 row_bcast:31 row_mask:0xc bank_mask:0xf
    v_cvt_pk_bf16_f32 v65, v98, v99
    v_readlane_b32 s26, v104, 63
    v_cvt_pk_bf16_f32 v66, v100, v101
    v_cvt_pk_bf16_f32 v67, v102, v103
    v_mul_f32 v104, s26, v6
    v_lshlrev_b32 v96, 16, v64
    v_cvt_pk_bf16_f32 v104, v104, v104
    v_and_b32 v97, 0xffff0000, v64
    v_lshlrev_b32 v104, 16, v104
    v_lshlrev_b32 v98, 16, v65
    v_add_f32 v104, 0x3727c5ac, v104
    v_and_b32 v99, 0xffff0000, v65
    v_cvt_pk_bf16_f32 v104, v104, v104
    v_lshlrev_b32 v100, 16, v66
    v_lshlrev_b32 v104, 16, v104
    v_and_b32 v101, 0xffff0000, v66
    v_sqrt_f32 v104, v104
    v_lshlrev_b32 v102, 16, v67
    v_cvt_pk_bf16_f32 v104, v104, v104
    v_and_b32 v103, 0xffff0000, v67
    v_lshlrev_b32 v104, 16, v104
    v_rcp_f32 v104, v104
    s_nop 0
    v_pk_mul_f32 v[96:97], v[96:97], v[104:105] op_sel_hi:[1,0]
    v_pk_mul_f32 v[98:99], v[98:99], v[104:105] op_sel_hi:[1,0]
    v_pk_mul_f32 v[100:101], v[100:101], v[104:105] op_sel_hi:[1,0]
    v_pk_mul_f32 v[102:103], v[102:103], v[104:105] op_sel_hi:[1,0]
    v_cvt_pk_bf16_f32 v64, v96, v97
    v_cvt_pk_bf16_f32 v65, v98, v99
    v_cvt_pk_bf16_f32 v66, v100, v101
    v_cvt_pk_bf16_f32 v67, v102, v103
    v_min_u32 v64, -2, v64
    v_min_u32 v65, -2, v65
    v_min_u32 v66, -2, v66
    v_min_u32 v67, -2, v67
    ds_write_b128 v148, v[64:67]
    s_waitcnt lgkmcnt(0)
    s_barrier
    ds_read_b128 v[120:123], v149
    ds_read_b128 v[124:127], v149 offset:8192
    s_sub_u32 s60, s21, 2097152
    s_waitcnt lgkmcnt(1)
    buffer_store_dwordx4 v[120:123], v13, s[4:7], s21 offen sc1
    s_waitcnt lgkmcnt(0)
    s_barrier
    buffer_store_dwordx4 v[124:127], v13, s[4:7], s60 offen sc1
    s_add_u32 m0, s20, 36864
    s_add_u32 s32, s19, 1056768
    buffer_load_dwordx4 v19, s[44:47], s32 offen offset:2048 lds
    v_lshrrev_b32 v28, 5, v1
    s_and_b32 s60, s12, 3
    s_and_b32 s61, s14, 3
    s_lshl_b32 s35, s13, 3
    s_add_u32 s35, s35, s61
    s_and_b32 s62, s12, 4
    s_add_u32 s35, s35, s62
    s_lshl_b32 s24, s62, 8
    s_lshr_b32 s34, s14, 2
    s_mul_i32 s61, s61, 6
    s_mul_i32 s26, s34, 3
    s_add_u32 s26, s26, s61
    s_add_u32 s26, s26, s13
    s_cmp_ge_u32 s26, 22
    s_cselect_b32 s61, 22, 0
    s_sub_u32 s26, s26, s61
    s_cmp_ge_u32 s26, 22
    s_cselect_b32 s61, 22, 0
    s_sub_u32 s26, s26, s61
    s_lshl_b32 s34, s34, 7
    v_lshrrev_b32 v9, 3, v1
    v_lshlrev_b32 v14, 10, v9
    v_and_b32 v9, 2, v9
    v_lshlrev_b32 v9, 1, v9
    v_and_b32 v10, 7, v1
    v_xor_b32 v9, v9, v10
    v_lshl_add_u32 v14, v9, 4, v14
    s_mul_i32 s61, s60, 360448
    s_add_u32 s61, s61, s34
    v_add_u32 v14, s61, v14
    s_lshl_b32 s19, s60, 14
    s_add_u32 s19, s19, 98304
    s_lshr_b32 s61, s60, 1
    s_mul_i32 s20, s61, 49152
    s_and_b32 s61, s60, 1
    s_mul_i32 s61, s61, 6144
    s_add_u32 s20, s20, s61
    s_lshl_b32 s30, s24, 3
    v_and_b32 v8, 1, v2
    v_mul_u32_u24 v24, 49536, v8
    v_lshrrev_b32 v9, 2, v3
    v_lshl_add_u32 v9, v28, 3, v9
    v_mul_u32_u24 v9, 96, v9
    v_add_u32 v24, v24, v9
    v_and_b32 v9, 3, v3
    v_lshl_add_u32 v24, v9, 3, v24
    v_mul_u32_u24 v13, 768, v8
    v_sub_u32 v13, 384, v13
    s_lshl_b32 s21, s16, 15
    s_add_u32 s21, s21, 6291456
    s_mul_i32 s61, s60, 22
    s_mul_i32 s61, s61, 43691
    s_lshr_b32 s61, s61, 17
    v_and_b32 v9, 7, v1
    v_add_u32 v9, s61, v9
    v_min_u32 v9, 28, v9
    v_mul_u32_u24 v10, 37, v9
    v_lshrrev_b32 v10, 8, v10
    v_mul_u32_u24 v6, 222, v10
    v_lshlrev_b32 v10, 5, v9
    v_sub_u32 v6, v10, v6
    v_cmp_eq_u32 vcc, 28, v9
    v_mov_b32 v10, 224
    s_nop 0
    v_cndmask_b32 v6, v6, v10, vcc
    s_lshr_b32 s61, s35, 5
    s_and_b32 s62, s35, 24
    s_add_u32 s61, s61, s62
    v_add_u32 v6, s61, v6
    s_and_b32 s61, s35, 7
    s_add_u32 s61, s61, 122880
    v_lshl_add_u32 v6, v6, 3, s61
    v_lshlrev_b32 v6, 7, v6
    s_lshr_b32 s61, s35, 3
    s_and_b32 s62, s35, 7
    s_lshl_b32 s62, s62, 5
    s_add_u32 s61, s61, s62
    v_and_b32 v9, 3, v1
    v_lshl_add_u32 v9, v9, 3, s61
    v_lshlrev_b32 v17, 10, v9
    v_add_u32 v17, 15729152, v17
    s_mul_i32 s61, s60, 1441792
    v_add_u32 v22, s61, v15
    s_lshl_b32 s25, s35, 12
    s_lshl_b32 s27, s35, 15
    s_lshl_b32 s23, s35, 10
    v_lshrrev_b32 v9, 2, v3
    v_lshl_add_u32 v9, v28, 2, v9
    v_lshlrev_b32 v9, 7, v9
    v_and_b32 v10, 1, v2
    v_lshl_add_u32 v9, v10, 5, v9
    v_and_b32 v10, 1, v3
    v_lshl_add_u32 v9, v10, 4, v9
    v_bfe_u32 v10, v3, 1, 1
    v_lshl_add_u32 v9, v10, 3, v9
    v_lshrrev_b32 v10, 3, v3
    v_lshl_add_u32 v4, v10, 6, v9
    s_lshl_b32 s61, s60, 5
    v_xor_b32 v4, s61, v4
    s_lshl_b32 s61, s34, 5
    s_add_u32 s27, s27, s61
    s_lshl_b32 s61, s60, 10
    s_add_u32 s27, s27, s61
    s_add_u32 s27, s27, 4194304
    v_and_b32 v10, 7, v1
    v_lshlrev_b32 v23, 18, v10
    v_bfe_u32 v10, v1, 3, 2
    v_lshl_add_u32 v23, v10, 10, v23
    v_lshl_add_u32 v23, v28, 4, v23
    s_lshl_b32 s61, s60, 5
    s_add_u32 s25, s25, s61
    s_add_u32 s25, s25, s34
    s_lshl_b32 s61, s24, 1
    s_add_u32 s61, s61, 102400
    v_add_u32 v5, s61, v15
    s_add_u32 s28, s19, s24
    s_add_u32 s29, s20, s24
    v_add_u32 v26, v24, v13
    v_add_u32 v14, s30, v14
    v_add_u32 v22, s23, v22
    s_lshl_b32 s32, s26, 16
    s_lshl_b32 s30, s30, 1
    s_sub_u32 s30, 8192, s30
    s_waitcnt vmcnt(0)
    s_barrier
    s_cmp_ge_u32 s17, 29
    s_cbranch_scc1 L_idle_o
    s_mov_b32 s34, 0
L_dredo:
    s_add_u32 s31, s21, 0
    buffer_load_dwordx4 v[116:119], v15, s[4:7], s31 offen offset:0 sc1
    buffer_load_dwordx4 v[120:123], v15, s[4:7], s31 offen offset:1024 sc1
    ds_read_b64_tr_b16 v[32:33], v24 offset:0
    ds_read_b64_tr_b16 v[34:35], v26 offset:0
    ds_read_b64_tr_b16 v[36:37], v24 offset:32
    ds_read_b64_tr_b16 v[38:39], v26 offset:32
    ds_read_b64_tr_b16 v[40:41], v24 offset:64
    ds_read_b64_tr_b16 v[42:43], v26 offset:64
    ds_read_b64_tr_b16 v[44:45], v24 offset:1536
    ds_read_b64_tr_b16 v[46:47], v26 offset:1536
    ds_read_b64_tr_b16 v[48:49], v24 offset:1568
    ds_read_b64_tr_b16 v[50:51], v26 offset:1568
    ds_read_b64_tr_b16 v[52:53], v24 offset:1600
    ds_read_b64_tr_b16 v[54:55], v26 offset:1600
    buffer_load_dwordx4 v[124:127], v15, s[4:7], s31 offen offset:2048 sc1
    buffer_load_dwordx4 v[128:131], v15, s[4:7], s31 offen offset:3072 sc1
    s_waitcnt vmcnt(3)
    v_max3_u32 v8, v116, v117, v118
    v_max_u32 v8, v8, v119
    v_cmp_eq_u32 vcc, -1, v8
    s_cbranch_vccnz Lpa0_r
Lpa0_ok:
    s_waitcnt lgkmcnt(10)
    v_mfma_f32_32x32x16_bf16 v[68:83], v[32:35], v[116:119], 0
    ds_read_b64_tr_b16 v[56:57], v24 offset:3072
    ds_read_b64_tr_b16 v[58:59], v26 offset:3072
    s_add_u32 s31, s21, 4096
    buffer_load_dwordx4 v[132:135], v15, s[4:7], s31 offen offset:0 sc1
    s_waitcnt lgkmcnt(10)
    v_mfma_f32_32x32x16_bf16 v[84:99], v[36:39], v[116:119], 0
    ds_read_b64_tr_b16 v[60:61], v24 offset:3104
    ds_read_b64_tr_b16 v[62:63], v26 offset:3104
    s_waitcnt vmcnt(3)
    v_max3_u32 v8, v120, v121, v122
    v_max_u32 v8, v8, v123
    v_cmp_eq_u32 vcc, -1, v8
    s_cbranch_vccnz Lpa1_r
Lpa1_ok:
    s_waitcnt lgkmcnt(10)
    v_mfma_f32_32x32x16_bf16 v[100:115], v[40:43], v[116:119], 0
    ds_read_b64_tr_b16 v[64:65], v24 offset:3136
    ds_read_b64_tr_b16 v[66:67], v26 offset:3136
    buffer_load_dwordx4 v[136:139], v15, s[4:7], s31 offen offset:1024 sc1
    s_waitcnt lgkmcnt(10)
    v_mfma_f32_32x32x16_bf16 v[68:83], v[44:47], v[120:123], v[68:83]
    ds_read_b64_tr_b16 v[32:33], v24 offset:4608
    ds_read_b64_tr_b16 v[34:35], v26 offset:4608
    buffer_load_dwordx4 v[140:143], v15, s[4:7], s31 offen offset:2048 sc1
    s_waitcnt lgkmcnt(10)
    v_mfma_f32_32x32x16_bf16 v[84:99], v[48:51], v[120:123], v[84:99]
    ds_read_b64_tr_b16 v[36:37], v24 offset:4640
    ds_read_b64_tr_b16 v[38:39], v26 offset:4640
    s_waitcnt vmcnt(4)
    v_max3_u32 v8, v124, v125, v126
    v_max_u32 v8, v8, v127
    v_cmp_eq_u32 vcc, -1, v8
    s_cbranch_vccnz Lpa2_r
Lpa2_ok:
    s_waitcnt lgkmcnt(10)
    v_mfma_f32_32x32x16_bf16 v[100:115], v[52:55], v[120:123], v[100:115]
    ds_read_b64_tr_b16 v[40:41], v24 offset:4672
    ds_read_b64_tr_b16 v[42:43], v26 offset:4672
    s_waitcnt lgkmcnt(10)
    v_mfma_f32_32x32x16_bf16 v[68:83], v[56:59], v[124:127], v[68:83]
    ds_read_b64_tr_b16 v[44:45], v24 offset:6144
    ds_read_b64_tr_b16 v[46:47], v26 offset:6144
    buffer_load_dwordx4 v[144:147], v15, s[4:7], s31 offen offset:3072 sc1
    s_waitcnt lgkmcnt(10)
    v_mfma_f32_32x32x16_bf16 v[84:99], v[60:63], v[124:127], v[84:99]
    ds_read_b64_tr_b16 v[48:49], v24 offset:6176
    ds_read_b64_tr_b16 v[50:51], v26 offset:6176
    s_waitcnt vmcnt(4)
    v_max3_u32 v8, v128, v129, v130
    v_max_u32 v8, v8, v131
    v_cmp_eq_u32 vcc, -1, v8
    s_cbranch_vccnz Lpa3_r
Lpa3_ok:
    s_waitcnt lgkmcnt(10)
    v_mfma_f32_32x32x16_bf16 v[100:115], v[64:67], v[124:127], v[100:115]
    ds_read_b64_tr_b16 v[52:53], v24 offset:6208
    ds_read_b64_tr_b16 v[54:55], v26 offset:6208
    s_waitcnt lgkmcnt(10)
    v_mfma_f32_32x32x16_bf16 v[68:83], v[32:35], v[128:131], v[68:83]
    ds_read_b64_tr_b16 v[56:57], v24 offset:7680
    ds_read_b64_tr_b16 v[58:59], v26 offset:7680
    s_add_u32 s31, s21, 8192
    buffer_load_dwordx4 v[148:151], v15, s[4:7], s31 offen offset:0 sc1
    s_waitcnt lgkmcnt(10)
    v_mfma_f32_32x32x16_bf16 v[84:99], v[36:39], v[128:131], v[84:99]
    ds_read_b64_tr_b16 v[60:61], v24 offset:7712
    ds_read_b64_tr_b16 v[62:63], v26 offset:7712
    s_waitcnt vmcnt(4)
    v_max3_u32 v8, v132, v133, v134
    v_max_u32 v8, v8, v135
    v_cmp_eq_u32 vcc, -1, v8
    s_cbranch_vccnz Lpa4_r
Lpa4_ok:
    s_waitcnt lgkmcnt(10)
    v_mfma_f32_32x32x16_bf16 v[100:115], v[40:43], v[128:131], v[100:115]
    ds_read_b64_tr_b16 v[64:65], v24 offset:7744
    ds_read_b64_tr_b16 v[66:67], v26 offset:7744
    buffer_load_dwordx4 v[152:155], v15, s[4:7], s31 offen offset:1024 sc1
    s_waitcnt lgkmcnt(10)
    v_mfma_f32_32x32x16_bf16 v[68:83], v[44:47], v[132:135], v[68:83]
    ds_read_b64_tr_b16 v[32:33], v24 offset:9216
    ds_read_b64_tr_b16 v[34:35], v26 offset:9216
    buffer_load_dwordx4 v[156:159], v15, s[4:7], s31 offen offset:2048 sc1
    s_waitcnt lgkmcnt(10)
    v_mfma_f32_32x32x16_bf16 v[84:99], v[48:51], v[132:135], v[84:99]
    ds_read_b64_tr_b16 v[36:37], v24 offset:9248
    ds_read_b64_tr_b16 v[38:39], v26 offset:9248
    s_waitcnt vmcnt(5)
    v_max3_u32 v8, v136, v137, v138
    v_max_u32 v8, v8, v139
    v_cmp_eq_u32 vcc, -1, v8
    s_cbranch_vccnz Lpa5_r
Lpa5_ok:
    s_waitcnt lgkmcnt(10)
    v_mfma_f32_32x32x16_bf16 v[100:115], v[52:55], v[132:135], v[100:115]
    ds_read_b64_tr_b16 v[40:41], v24 offset:9280
    ds_read_b64_tr_b16 v[42:43], v26 offset:9280
    s_waitcnt lgkmcnt(10)
    v_mfma_f32_32x32x16_bf16 v[68:83], v[56:59], v[136:139], v[68:83]
    ds_read_b64_tr_b16 v[44:45], v24 offset:10752
    ds_read_b64_tr_b16 v[46:47], v26 offset:10752
    buffer_load_dwordx4 v[160:163], v15, s[4:7], s31 offen offset:3072 sc1
    s_waitcnt lgkmcnt(10)
    v_mfma_f32_32x32x16_bf16 v[84:99], v[60:63], v[136:139], v[84:99]
    ds_read_b64_tr_b16 v[48:49], v24 offset:10784
    ds_read_b64_tr_b16 v[50:51], v26 offset:10784
    s_waitcnt vmcnt(5)
    v_max3_u32 v8, v140, v141, v142
    v_max_u32 v8, v8, v143
    v_cmp_eq_u32 vcc, -1, v8
    s_cbranch_vccnz Lpa6_r
Lpa6_ok:
    s_waitcnt lgkmcnt(10)
    v_mfma_f32_32x32x16_bf16 v[100:115], v[64:67], v[136:139], v[100:115]
    ds_read_b64_tr_b16 v[52:53], v24 offset:10816
    ds_read_b64_tr_b16 v[54:55], v26 offset:10816
    s_cmp_lt_u32 s12, 4
    s_cbranch_scc1 L_pa
    s_setprio 1
L_pa:
    s_waitcnt lgkmcnt(10)
    v_mfma_f32_32x32x16_bf16 v[68:83], v[32:35], v[140:143], v[68:83]
    ds_read_b64_tr_b16 v[56:57], v24 offset:12288
    ds_read_b64_tr_b16 v[58:59], v26 offset:12288
    s_add_u32 s31, s21, 12288
    buffer_load_dwordx4 v[164:167], v15, s[4:7], s31 offen offset:0 sc1
    s_waitcnt lgkmcnt(10)
    v_mfma_f32_32x32x16_bf16 v[84:99], v[36:39], v[140:143], v[84:99]
    ds_read_b64_tr_b16 v[60:61], v24 offset:12320
    ds_read_b64_tr_b16 v[62:63], v26 offset:12320
    s_waitcnt vmcnt(5)
    v_max3_u32 v8, v144, v145, v146
    v_max_u32 v8, v8, v147
    v_cmp_eq_u32 vcc, -1, v8
    s_cbranch_vccnz Lpa7_r
Lpa7_ok:
    s_waitcnt lgkmcnt(10)
    v_mfma_f32_32x32x16_bf16 v[100:115], v[40:43], v[140:143], v[100:115]
    ds_read_b64_tr_b16 v[64:65], v24 offset:12352
    ds_read_b64_tr_b16 v[66:67], v26 offset:12352
    buffer_load_dwordx4 v[168:171], v15, s[4:7], s31 offen offset:1024 sc1
    s_waitcnt lgkmcnt(10)
    v_mfma_f32_32x32x16_bf16 v[68:83], v[44:47], v[144:147], v[68:83]
    ds_read_b64_tr_b16 v[32:33], v24 offset:13824
    ds_read_b64_tr_b16 v[34:35], v26 offset:13824
    buffer_load_dwordx4 v[172:175], v15, s[4:7], s31 offen offset:2048 sc1
    s_waitcnt lgkmcnt(10)
    v_mfma_f32_32x32x16_bf16 v[84:99], v[48:51], v[144:147], v[84:99]
    ds_read_b64_tr_b16 v[36:37], v24 offset:13856
    ds_read_b64_tr_b16 v[38:39], v26 offset:13856
    s_waitcnt vmcnt(6)
    s_waitcnt lgkmcnt(10)
    v_mfma_f32_32x32x16_bf16 v[100:115], v[52:55], v[144:147], v[100:115]
    ds_read_b64_tr_b16 v[40:41], v24 offset:13888
    ds_read_b64_tr_b16 v[42:43], v26 offset:13888
    s_waitcnt lgkmcnt(10)
    v_mfma_f32_32x32x16_bf16 v[68:83], v[56:59], v[148:151], v[68:83]
    ds_read_b64_tr_b16 v[44:45], v24 offset:15360
    ds_read_b64_tr_b16 v[46:47], v26 offset:15360
    buffer_load_dwordx4 v[176:179], v15, s[4:7], s31 offen offset:3072 sc1
    s_waitcnt lgkmcnt(10)
    v_mfma_f32_32x32x16_bf16 v[84:99], v[60:63], v[148:151], v[84:99]
    ds_read_b64_tr_b16 v[48:49], v24 offset:15392
    ds_read_b64_tr_b16 v[50:51], v26 offset:15392
    s_waitcnt vmcnt(6)
    s_waitcnt lgkmcnt(10)
    v_mfma_f32_32x32x16_bf16 v[100:115], v[64:67], v[148:151], v[100:115]
    ds_read_b64_tr_b16 v[52:53], v24 offset:15424
    ds_read_b64_tr_b16 v[54:55], v26 offset:15424
    s_waitcnt lgkmcnt(10)
    v_mfma_f32_32x32x16_bf16 v[68:83], v[32:35], v[152:155], v[68:83]
    ds_read_b64_tr_b16 v[56:57], v24 offset:16896
    ds_read_b64_tr_b16 v[58:59], v26 offset:16896
    s_add_u32 s31, s21, 16384
    buffer_load_dwordx4 v[180:183], v15, s[4:7], s31 offen offset:0 sc1
    s_waitcnt lgkmcnt(10)
    v_mfma_f32_32x32x16_bf16 v[84:99], v[36:39], v[152:155], v[84:99]
    ds_read_b64_tr_b16 v[60:61], v24 offset:16928
    ds_read_b64_tr_b16 v[62:63], v26 offset:16928
    s_waitcnt vmcnt(6)
    s_waitcnt lgkmcnt(10)
    v_mfma_f32_32x32x16_bf16 v[100:115], v[40:43], v[152:155], v[100:115]
    ds_read_b64_tr_b16 v[64:65], v24 offset:16960
    ds_read_b64_tr_b16 v[66:67], v26 offset:16960
    buffer_load_dwordx4 v[184:187], v15, s[4:7], s31 offen offset:1024 sc1
    s_waitcnt lgkmcnt(10)
    v_mfma_f32_32x32x16_bf16 v[68:83], v[44:47], v[156:159], v[68:83]
    ds_read_b64_tr_b16 v[32:33], v24 offset:18432
    ds_read_b64_tr_b16 v[34:35], v26 offset:18432
    buffer_load_dwordx4 v[188:191], v15, s[4:7], s31 offen offset:2048 sc1
    s_waitcnt lgkmcnt(10)
    v_mfma_f32_32x32x16_bf16 v[84:99], v[48:51], v[156:159], v[84:99]
    ds_read_b64_tr_b16 v[36:37], v24 offset:18464
    ds_read_b64_tr_b16 v[38:39], v26 offset:18464
    s_waitcnt vmcnt(7)
    s_waitcnt lgkmcnt(10)
    v_mfma_f32_32x32x16_bf16 v[100:115], v[52:55], v[156:159], v[100:115]
    ds_read_b64_tr_b16 v[40:41], v24 offset:18496
    ds_read_b64_tr_b16 v[42:43], v26 offset:18496
    s_waitcnt lgkmcnt(10)
    v_mfma_f32_32x32x16_bf16 v[68:83], v[56:59], v[160:163], v[68:83]
    ds_read_b64_tr_b16 v[44:45], v24 offset:19968
    ds_read_b64_tr_b16 v[46:47], v26 offset:19968
    buffer_load_dwordx4 v[192:195], v15, s[4:7], s31 offen offset:3072 sc1
    s_waitcnt lgkmcnt(10)
    v_mfma_f32_32x32x16_bf16 v[84:99], v[60:63], v[160:163], v[84:99]
    ds_read_b64_tr_b16 v[48:49], v24 offset:20000
    ds_read_b64_tr_b16 v[50:51], v26 offset:20000
    s_waitcnt vmcnt(7)
    s_waitcnt lgkmcnt(10)
    v_mfma_f32_32x32x16_bf16 v[100:115], v[64:67], v[160:163], v[100:115]
    ds_read_b64_tr_b16 v[52:53], v24 offset:20032
    ds_read_b64_tr_b16 v[54:55], v26 offset:20032
    s_waitcnt lgkmcnt(10)
    v_mfma_f32_32x32x16_bf16 v[68:83], v[32:35], v[164:167], v[68:83]
    ds_read_b64_tr_b16 v[56:57], v24 offset:21504
    ds_read_b64_tr_b16 v[58:59], v26 offset:21504
    s_add_u32 s31, s21, 20480
    buffer_load_dwordx4 v[196:199], v15, s[4:7], s31 offen offset:0 sc1
    s_waitcnt lgkmcnt(10)
    v_mfma_f32_32x32x16_bf16 v[84:99], v[36:39], v[164:167], v[84:99]
    ds_read_b64_tr_b16 v[60:61], v24 offset:21536
    ds_read_b64_tr_b16 v[62:63], v26 offset:21536
    s_waitcnt vmcnt(7)
    s_waitcnt lgkmcnt(10)
    v_mfma_f32_32x32x16_bf16 v[100:115], v[40:43], v[164:167], v[100:115]
    ds_read_b64_tr_b16 v[64:65], v24 offset:21568
    ds_read_b64_tr_b16 v[66:67], v26 offset:21568
    buffer_load_dwordx4 v[200:203], v15, s[4:7], s31 offen offset:1024 sc1
    s_waitcnt lgkmcnt(10)
    v_mfma_f32_32x32x16_bf16 v[68:83], v[44:47], v[168:171], v[68:83]
    ds_read_b64_tr_b16 v[32:33], v24 offset:23040
    ds_read_b64_tr_b16 v[34:35], v26 offset:23040
    buffer_load_dwordx4 v[204:207], v15, s[4:7], s31 offen offset:2048 sc1
    s_waitcnt lgkmcnt(10)
    v_mfma_f32_32x32x16_bf16 v[84:99], v[48:51], v[168:171], v[84:99]
    ds_read_b64_tr_b16 v[36:37], v24 offset:23072
    ds_read_b64_tr_b16 v[38:39], v26 offset:23072
    s_waitcnt vmcnt(8)
    s_waitcnt lgkmcnt(10)
    v_mfma_f32_32x32x16_bf16 v[100:115], v[52:55], v[168:171], v[100:115]
    ds_read_b64_tr_b16 v[40:41], v24 offset:23104
    ds_read_b64_tr_b16 v[42:43], v26 offset:23104
    s_waitcnt lgkmcnt(10)
    v_mfma_f32_32x32x16_bf16 v[68:83], v[56:59], v[172:175], v[68:83]
    ds_read_b64_tr_b16 v[44:45], v24 offset:24576
    ds_read_b64_tr_b16 v[46:47], v26 offset:24576
    buffer_load_dwordx4 v[208:211], v15, s[4:7], s31 offen offset:3072 sc1
    s_waitcnt lgkmcnt(10)
    v_mfma_f32_32x32x16_bf16 v[84:99], v[60:63], v[172:175], v[84:99]
    ds_read_b64_tr_b16 v[48:49], v24 offset:24608
    ds_read_b64_tr_b16 v[50:51], v26 offset:24608
    s_waitcnt vmcnt(8)
    s_waitcnt lgkmcnt(10)
    v_mfma_f32_32x32x16_bf16 v[100:115], v[64:67], v[172:175], v[100:115]
    ds_read_b64_tr_b16 v[52:53], v24 offset:24640
    ds_read_b64_tr_b16 v[54:55], v26 offset:24640
    s_waitcnt lgkmcnt(10)
    v_mfma_f32_32x32x16_bf16 v[68:83], v[32:35], v[176:179], v[68:83]
    ds_read_b64_tr_b16 v[56:57], v24 offset:26112
    ds_read_b64_tr_b16 v[58:59], v26 offset:26112
    s_add_u32 s31, s21, 24576
    buffer_load_dwordx4 v[212:215], v15, s[4:7], s31 offen offset:0 sc1
    s_waitcnt lgkmcnt(10)
    v_mfma_f32_32x32x16_bf16 v[84:99], v[36:39], v[176:179], v[84:99]
    ds_read_b64_tr_b16 v[60:61], v24 offset:26144
    ds_read_b64_tr_b16 v[62:63], v26 offset:26144
    s_waitcnt vmcnt(8)
    s_waitcnt lgkmcnt(10)
    v_mfma_f32_32x32x16_bf16 v[100:115], v[40:43], v[176:179], v[100:115]
    ds_read_b64_tr_b16 v[64:65], v24 offset:26176
    ds_read_b64_tr_b16 v[66:67], v26 offset:26176
    buffer_load_dwordx4 v[216:219], v15, s[4:7], s31 offen offset:1024 sc1
    s_waitcnt lgkmcnt(10)
    v_mfma_f32_32x32x16_bf16 v[68:83], v[44:47], v[180:183], v[68:83]
    ds_read_b64_tr_b16 v[32:33], v24 offset:27648
    ds_read_b64_tr_b16 v[34:35], v26 offset:27648
    buffer_load_dwordx4 v[220:223], v15, s[4:7], s31 offen offset:2048 sc1
    s_waitcnt lgkmcnt(10)
    v_mfma_f32_32x32x16_bf16 v[84:99], v[48:51], v[180:183], v[84:99]
    ds_read_b64_tr_b16 v[36:37], v24 offset:27680
    ds_read_b64_tr_b16 v[38:39], v26 offset:27680
    s_waitcnt vmcnt(9)
    s_waitcnt lgkmcnt(10)
    v_mfma_f32_32x32x16_bf16 v[100:115], v[52:55], v[180:183], v[100:115]
    ds_read_b64_tr_b16 v[40:41], v24 offset:27712
    ds_read_b64_tr_b16 v[42:43], v26 offset:27712
    s_waitcnt lgkmcnt(10)
    v_mfma_f32_32x32x16_bf16 v[68:83], v[56:59], v[184:187], v[68:83]
    ds_read_b64_tr_b16 v[44:45], v24 offset:29184
    ds_read_b64_tr_b16 v[46:47], v26 offset:29184
    buffer_load_dwordx4 v[224:227], v15, s[4:7], s31 offen offset:3072 sc1
    s_waitcnt lgkmcnt(10)
    v_mfma_f32_32x32x16_bf16 v[84:99], v[60:63], v[184:187], v[84:99]
    ds_read_b64_tr_b16 v[48:49], v24 offset:29216
    ds_read_b64_tr_b16 v[50:51], v26 offset:29216
    s_waitcnt vmcnt(9)
    s_waitcnt lgkmcnt(10)
    v_mfma_f32_32x32x16_bf16 v[100:115], v[64:67], v[184:187], v[100:115]
    ds_read_b64_tr_b16 v[52:53], v24 offset:29248
    ds_read_b64_tr_b16 v[54:55], v26 offset:29248
    s_waitcnt lgkmcnt(10)
    v_mfma_f32_32x32x16_bf16 v[68:83], v[32:35], v[188:191], v[68:83]
    ds_read_b64_tr_b16 v[56:57], v24 offset:30720
    ds_read_b64_tr_b16 v[58:59], v26 offset:30720
    s_add_u32 s31, s21, 28672
    buffer_load_dwordx4 v[228:231], v15, s[4:7], s31 offen offset:0 sc1
    s_waitcnt lgkmcnt(10)
    v_mfma_f32_32x32x16_bf16 v[84:99], v[36:39], v[188:191], v[84:99]
    ds_read_b64_tr_b16 v[60:61], v24 offset:30752
    ds_read_b64_tr_b16 v[62:63], v26 offset:30752
    s_waitcnt vmcnt(9)
    s_waitcnt lgkmcnt(10)
    v_mfma_f32_32x32x16_bf16 v[100:115], v[40:43], v[188:191], v[100:115]
    ds_read_b64_tr_b16 v[64:65], v24 offset:30784
    ds_read_b64_tr_b16 v[66:67], v26 offset:30784
    buffer_load_dwordx4 v[232:235], v15, s[4:7], s31 offen offset:1024 sc1
    s_waitcnt lgkmcnt(10)
    v_mfma_f32_32x32x16_bf16 v[68:83], v[44:47], v[192:195], v[68:83]
    ds_read_b64_tr_b16 v[32:33], v24 offset:32256
    ds_read_b64_tr_b16 v[34:35], v26 offset:32256
    buffer_load_dwordx4 v[236:239], v15, s[4:7], s31 offen offset:2048 sc1
    s_waitcnt lgkmcnt(10)
    v_mfma_f32_32x32x16_bf16 v[84:99], v[48:51], v[192:195], v[84:99]
    ds_read_b64_tr_b16 v[36:37], v24 offset:32288
    ds_read_b64_tr_b16 v[38:39], v26 offset:32288
    s_waitcnt vmcnt(10)
    s_waitcnt lgkmcnt(10)
    v_mfma_f32_32x32x16_bf16 v[100:115], v[52:55], v[192:195], v[100:115]
    ds_read_b64_tr_b16 v[40:41], v24 offset:32320
    ds_read_b64_tr_b16 v[42:43], v26 offset:32320
    s_add_u32 m0, s28, 0
    s_lshl_b32 s18, s26, 14
    buffer_load_dwordx4 v14, s[48:51], s18 offen lds
    s_waitcnt lgkmcnt(10)
    v_mfma_f32_32x32x16_bf16 v[68:83], v[56:59], v[196:199], v[68:83]
    ds_read_b64_tr_b16 v[44:45], v24 offset:33792
    ds_read_b64_tr_b16 v[46:47], v26 offset:33792
    buffer_load_dwordx4 v[240:243], v15, s[4:7], s31 offen offset:3072 sc1
    s_waitcnt lgkmcnt(10)
    v_mfma_f32_32x32x16_bf16 v[84:99], v[60:63], v[196:199], v[84:99]
    ds_read_b64_tr_b16 v[48:49], v24 offset:35328
    ds_read_b64_tr_b16 v[50:51], v26 offset:35328
    s_waitcnt vmcnt(11)
    s_waitcnt lgkmcnt(10)
    v_mfma_f32_32x32x16_bf16 v[100:115], v[64:67], v[196:199], v[100:115]
    ds_read_b64_tr_b16 v[52:53], v24 offset:36864
    ds_read_b64_tr_b16 v[54:55], v26 offset:36864
    s_add_u32 m0, s28, 2048
    s_add_u32 s18, s18, 16384
    s_cmp_eq_u32 s18, 360448
    s_cselect_b32 s18, 0, s18
    buffer_load_dwordx4 v14, s[48:51], s18 offen lds
    s_waitcnt lgkmcnt(10)
    v_mfma_f32_32x32x16_bf16 v[68:83], v[32:35], v[200:203], v[68:83]
    ds_read_b64_tr_b16 v[56:57], v24 offset:38400
    ds_read_b64_tr_b16 v[58:59], v26 offset:38400
    s_waitcnt lgkmcnt(10)
    v_mfma_f32_32x32x16_bf16 v[84:99], v[36:39], v[200:203], v[84:99]
    ds_read_b64_tr_b16 v[60:61], v24 offset:39936
    ds_read_b64_tr_b16 v[62:63], v26 offset:39936
    s_waitcnt vmcnt(11)
    s_waitcnt lgkmcnt(10)
    v_mfma_f32_32x32x16_bf16 v[100:115], v[40:43], v[200:203], v[100:115]
    ds_read_b64_tr_b16 v[64:65], v24 offset:41472
    ds_read_b64_tr_b16 v[66:67], v26 offset:41472
    s_add_u32 m0, s28, 4096
    s_add_u32 s18, s18, 16384
    s_cmp_eq_u32 s18, 360448
    s_cselect_b32 s18, 0, s18
    buffer_load_dwordx4 v14, s[48:51], s18 offen lds
    s_waitcnt lgkmcnt(10)
    v_mfma_f32_32x32x16_bf16 v[68:83], v[44:47], v[204:207], v[68:83]
    ds_read_b64_tr_b16 v[32:33], v24 offset:43008
    ds_read_b64_tr_b16 v[34:35], v26 offset:43008
    s_add_u32 m0, s28, 6144
    s_add_u32 s18, s18, 16384
    s_cmp_eq_u32 s18, 360448
    s_cselect_b32 s18, 0, s18
    buffer_load_dwordx4 v14, s[48:51], s18 offen lds
    s_waitcnt vmcnt(12)
    s_waitcnt lgkmcnt(10)
    v_mfma_f32_32x32x16_bf16 v[68:83], v[48:51], v[208:211], v[68:83]
    ds_read_b64_tr_b16 v[36:37], v24 offset:44544
    ds_read_b64_tr_b16 v[38:39], v26 offset:44544
    s_add_u32 m0, s28, 8192
    s_add_u32 s18, s18, 16384
    s_cmp_eq_u32 s18, 360448
    s_cselect_b32 s18, 0, s18
    buffer_load_dwordx4 v14, s[48:51], s18 offen lds
    s_waitcnt vmcnt(12)
    s_mov_b32 s60, 0xbdd2d3e8
    v_mov_b32 v10, 0xc0135761
    s_waitcnt lgkmcnt(10)
    v_mfma_f32_32x32x16_bf16 v[68:83], v[52:55], v[212:215], v[68:83]
    ds_read_b64_tr_b16 v[40:41], v24 offset:46080
    ds_read_b64_tr_b16 v[42:43], v26 offset:46080
    s_add_u32 m0, s28, 10240
    s_add_u32 s18, s18, 16384
    s_cmp_eq_u32 s18, 360448
    s_cselect_b32 s18, 0, s18
    buffer_load_dwordx4 v14, s[48:51], s18 offen lds
    s_waitcnt vmcnt(12)
    s_waitcnt lgkmcnt(10)
    v_mfma_f32_32x32x16_bf16 v[68:83], v[56:59], v[216:219], v[68:83]
    ds_read_b64_tr_b16 v[44:45], v24 offset:47616
    ds_read_b64_tr_b16 v[46:47], v26 offset:47616
    s_add_u32 m0, s28, 12288
    s_add_u32 s18, s18, 16384
    s_cmp_eq_u32 s18, 360448
    s_cselect_b32 s18, 0, s18
    buffer_load_dwordx4 v14, s[48:51], s18 offen lds
    s_waitcnt vmcnt(12)
    s_waitcnt lgkmcnt(10)
    v_mfma_f32_32x32x16_bf16 v[68:83], v[60:63], v[220:223], v[68:83]
    ds_read_b64_tr_b16 v[48:49], v24 offset:33824
    ds_read_b64_tr_b16 v[50:51], v26 offset:33824
    s_add_u32 m0, s28, 14336
    s_add_u32 s18, s18, 16384
    s_cmp_eq_u32 s18, 360448
    s_cselect_b32 s18, 0, s18
    buffer_load_dwordx4 v14, s[48:51], s18 offen lds
    s_waitcnt vmcnt(12)
    s_waitcnt lgkmcnt(10)
    v_mfma_f32_32x32x16_bf16 v[68:83], v[64:67], v[224:227], v[68:83]
    ds_read_b64_tr_b16 v[52:53], v24 offset:35360
    ds_read_b64_tr_b16 v[54:55], v26 offset:35360
    s_waitcnt vmcnt(11)
    s_waitcnt lgkmcnt(10)
    v_mfma_f32_32x32x16_bf16 v[68:83], v[32:35], v[228:231], v[68:83]
    ds_read_b64_tr_b16 v[56:57], v24 offset:36896
    ds_read_b64_tr_b16 v[58:59], v26 offset:36896
    s_waitcnt vmcnt(10)
    s_waitcnt lgkmcnt(10)
    v_mfma_f32_32x32x16_bf16 v[68:83], v[36:39], v[232:235], v[68:83]
    ds_read_b64_tr_b16 v[60:61], v24 offset:38432
    ds_read_b64_tr_b16 v[62:63], v26 offset:38432
    s_waitcnt vmcnt(9)
    s_waitcnt lgkmcnt(10)
    v_mfma_f32_32x32x16_bf16 v[68:83], v[40:43], v[236:239], v[68:83]
    ds_read_b64_tr_b16 v[64:65], v24 offset:39968
    ds_read_b64_tr_b16 v[66:67], v26 offset:39968
    s_waitcnt vmcnt(7)
    s_waitcnt lgkmcnt(10)
    v_mfma_f32_32x32x16_bf16 v[68:83], v[44:47], v[240:243], v[68:83]
    ds_read_b64_tr_b16 v[32:33], v24 offset:41504
    ds_read_b64_tr_b16 v[34:35], v26 offset:41504
    s_waitcnt lgkmcnt(10)
    v_mfma_f32_32x32x16_bf16 v[84:99], v[48:51], v[204:207], v[84:99]
    ds_read_b64_tr_b16 v[36:37], v24 offset:43040
    ds_read_b64_tr_b16 v[38:39], v26 offset:43040
    s_nop 5
    v_cmp_u_f32 vcc, v68, v68
    s_cbranch_vccnz L_nt_r
L_nt_ok:
    v_mul_f32 v116, v68, v68
    v_mul_f32 v117, v69, v69
    v_mul_f32 v118, v70, v70
    v_mul_f32 v119, v71, v71
    v_mul_f32 v120, v72, v72
    v_mul_f32 v121, v73, v73
    v_mul_f32 v122, v74, v74
    s_waitcnt lgkmcnt(10)
    v_mfma_f32_32x32x16_bf16 v[84:99], v[52:55], v[208:211], v[84:99]
    ds_read_b64_tr_b16 v[40:41], v24 offset:44576
    ds_read_b64_tr_b16 v[42:43], v26 offset:44576
    v_mul_f32 v123, v75, v75
    v_fma_f32 v116, v116, s60, v10
    v_fma_f32 v117, v117, s60, v10
    v_fma_f32 v118, v118, s60, v10
    v_fma_f32 v119, v119, s60, v10
    v_fma_f32 v120, v120, s60, v10
    v_fma_f32 v121, v121, s60, v10
    s_waitcnt lgkmcnt(10)
    v_mfma_f32_32x32x16_bf16 v[84:99], v[56:59], v[212:215], v[84:99]
    ds_read_b64_tr_b16 v[44:45], v24 offset:46112
    ds_read_b64_tr_b16 v[46:47], v26 offset:46112
    v_fma_f32 v122, v122, s60, v10
    v_fma_f32 v123, v123, s60, v10
    v_mul_f32 v116, v116, v68
    v_mul_f32 v117, v117, v69
    v_mul_f32 v118, v118, v70
    v_mul_f32 v119, v119, v71
    v_mul_f32 v120, v120, v72
    s_waitcnt lgkmcnt(10)
    v_mfma_f32_32x32x16_bf16 v[84:99], v[60:63], v[216:219], v[84:99]
    ds_read_b64_tr_b16 v[48:49], v24 offset:47648
    ds_read_b64_tr_b16 v[50:51], v26 offset:47648
    v_mul_f32 v121, v121, v73
    v_mul_f32 v122, v122, v74
    v_mul_f32 v123, v123, v75
    v_exp_f32 v116, v116
    v_mul_f32 v76, v76, v68
    v_exp_f32 v117, v117
    v_mul_f32 v77, v77, v69
    s_waitcnt lgkmcnt(10)
    v_mfma_f32_32x32x16_bf16 v[84:99], v[64:67], v[220:223], v[84:99]
    ds_read_b64_tr_b16 v[52:53], v24 offset:33856
    ds_read_b64_tr_b16 v[54:55], v26 offset:33856
    v_exp_f32 v118, v118
    v_mul_f32 v78, v78, v70
    v_exp_f32 v119, v119
    v_mul_f32 v79, v79, v71
    v_exp_f32 v120, v120
    v_mul_f32 v80, v80, v72
    v_exp_f32 v121, v121
    s_waitcnt lgkmcnt(10)
    v_mfma_f32_32x32x16_bf16 v[84:99], v[32:35], v[224:227], v[84:99]
    ds_read_b64_tr_b16 v[56:57], v24 offset:35392
    ds_read_b64_tr_b16 v[58:59], v26 offset:35392
    v_mul_f32 v81, v81, v73
    v_exp_f32 v122, v122
    v_mul_f32 v82, v82, v74
    v_exp_f32 v123, v123
    v_mul_f32 v83, v83, v75
    v_add_f32 v116, 1.0, v116
    v_add_f32 v117, 1.0, v117
    s_waitcnt lgkmcnt(10)
    v_mfma_f32_32x32x16_bf16 v[84:99], v[36:39], v[228:231], v[84:99]
    ds_read_b64_tr_b16 v[60:61], v24 offset:36928
    ds_read_b64_tr_b16 v[62:63], v26 offset:36928
    v_add_f32 v118, 1.0, v118
    v_add_f32 v119, 1.0, v119
    v_add_f32 v120, 1.0, v120
    v_add_f32 v121, 1.0, v121
    v_add_f32 v122, 1.0, v122
    v_add_f32 v123, 1.0, v123
    v_rcp_f32 v116, v116
    s_waitcnt lgkmcnt(10)
    v_mfma_f32_32x32x16_bf16 v[84:99], v[40:43], v[232:235], v[84:99]
    ds_read_b64_tr_b16 v[64:65], v24 offset:38464
    ds_read_b64_tr_b16 v[66:67], v26 offset:38464
    v_rcp_f32 v117, v117
    v_rcp_f32 v118, v118
    v_rcp_f32 v119, v119
    v_rcp_f32 v120, v120
    v_rcp_f32 v121, v121
    v_rcp_f32 v122, v122
    v_rcp_f32 v123, v123
    s_waitcnt lgkmcnt(10)
    v_mfma_f32_32x32x16_bf16 v[84:99], v[44:47], v[236:239], v[84:99]
    ds_read_b64_tr_b16 v[32:33], v24 offset:40000
    ds_read_b64_tr_b16 v[34:35], v26 offset:40000
    s_mov_b32 s31, 0
    v_mul_f32 v116, v116, v76
    v_mul_f32 v117, v117, v77
    v_mul_f32 v118, v118, v78
    v_mul_f32 v119, v119, v79
    v_mul_f32 v120, v120, v80
    v_mul_f32 v121, v121, v81
    s_waitcnt lgkmcnt(10)
    v_mfma_f32_32x32x16_bf16 v[84:99], v[48:51], v[240:243], v[84:99]
    ds_read_b64_tr_b16 v[36:37], v24 offset:41536
    ds_read_b64_tr_b16 v[38:39], v26 offset:41536
    v_mul_f32 v122, v122, v82
    v_mul_f32 v123, v123, v83
    v_cvt_pk_bf16_f32 v68, v116, v117
    v_cvt_pk_bf16_f32 v69, v118, v119
    v_cvt_pk_bf16_f32 v70, v120, v121
    v_cvt_pk_bf16_f32 v71, v122, v123
    buffer_store_dwordx4 v[68:71], v16, s[56:59], s31 offen sc1
    s_waitcnt lgkmcnt(10)
    v_mfma_f32_32x32x16_bf16 v[100:115], v[52:55], v[204:207], v[100:115]
    ds_read_b64_tr_b16 v[40:41], v24 offset:43072
    ds_read_b64_tr_b16 v[42:43], v26 offset:43072
    v_mul_f32 v116, v84, v84
    v_mul_f32 v117, v85, v85
    v_mul_f32 v118, v86, v86
    v_mul_f32 v119, v87, v87
    v_mul_f32 v120, v88, v88
    v_mul_f32 v121, v89, v89
    v_mul_f32 v122, v90, v90
    s_waitcnt lgkmcnt(10)
    v_mfma_f32_32x32x16_bf16 v[100:115], v[56:59], v[208:211], v[100:115]
    ds_read_b64_tr_b16 v[44:45], v24 offset:44608
    ds_read_b64_tr_b16 v[46:47], v26 offset:44608
    v_mul_f32 v123, v91, v91
    v_fma_f32 v116, v116, s60, v10
    v_fma_f32 v117, v117, s60, v10
    v_fma_f32 v118, v118, s60, v10
    v_fma_f32 v119, v119, s60, v10
    v_fma_f32 v120, v120, s60, v10
    v_fma_f32 v121, v121, s60, v10
    s_waitcnt lgkmcnt(10)
    v_mfma_f32_32x32x16_bf16 v[100:115], v[60:63], v[212:215], v[100:115]
    ds_read_b64_tr_b16 v[48:49], v24 offset:46144
    ds_read_b64_tr_b16 v[50:51], v26 offset:46144
    v_fma_f32 v122, v122, s60, v10
    v_fma_f32 v123, v123, s60, v10
    v_mul_f32 v116, v116, v84
    v_mul_f32 v117, v117, v85
    v_mul_f32 v118, v118, v86
    v_mul_f32 v119, v119, v87
    v_mul_f32 v120, v120, v88
    s_waitcnt lgkmcnt(10)
    v_mfma_f32_32x32x16_bf16 v[100:115], v[64:67], v[216:219], v[100:115]
    ds_read_b64_tr_b16 v[52:53], v24 offset:47680
    ds_read_b64_tr_b16 v[54:55], v26 offset:47680
    v_mul_f32 v121, v121, v89
    v_mul_f32 v122, v122, v90
    v_mul_f32 v123, v123, v91
    v_exp_f32 v116, v116
    v_mul_f32 v92, v92, v84
    v_exp_f32 v117, v117
    v_mul_f32 v93, v93, v85
    s_waitcnt lgkmcnt(10)
    v_mfma_f32_32x32x16_bf16 v[100:115], v[32:35], v[220:223], v[100:115]
    v_exp_f32 v118, v118
    v_mul_f32 v94, v94, v86
    v_exp_f32 v119, v119
    v_mul_f32 v95, v95, v87
    v_exp_f32 v120, v120
    v_mul_f32 v96, v96, v88
    v_exp_f32 v121, v121
    s_waitcnt lgkmcnt(8)
    v_mfma_f32_32x32x16_bf16 v[100:115], v[36:39], v[224:227], v[100:115]
    v_mul_f32 v97, v97, v89
    v_exp_f32 v122, v122
    v_mul_f32 v98, v98, v90
    v_exp_f32 v123, v123
    v_mul_f32 v99, v99, v91
    v_add_f32 v116, 1.0, v116
    v_add_f32 v117, 1.0, v117
    s_waitcnt lgkmcnt(6)
    v_mfma_f32_32x32x16_bf16 v[100:115], v[40:43], v[228:231], v[100:115]
    v_add_f32 v118, 1.0, v118
    v_add_f32 v119, 1.0, v119
    v_add_f32 v120, 1.0, v120
    v_add_f32 v121, 1.0, v121
    v_add_f32 v122, 1.0, v122
    v_add_f32 v123, 1.0, v123
    v_rcp_f32 v116, v116
    s_waitcnt lgkmcnt(4)
    v_mfma_f32_32x32x16_bf16 v[100:115], v[44:47], v[232:235], v[100:115]
    v_rcp_f32 v117, v117
    v_rcp_f32 v118, v118
    v_rcp_f32 v119, v119
    v_rcp_f32 v120, v120
    v_rcp_f32 v121, v121
    v_rcp_f32 v122, v122
    v_rcp_f32 v123, v123
    s_waitcnt lgkmcnt(2)
    v_mfma_f32_32x32x16_bf16 v[100:115], v[48:51], v[236:239], v[100:115]
    s_mov_b32 s31, 65536
    v_mul_f32 v116, v116, v92
    v_mul_f32 v117, v117, v93
    v_mul_f32 v118, v118, v94
    v_mul_f32 v119, v119, v95
    v_mul_f32 v120, v120, v96
    v_mul_f32 v121, v121, v97
    s_waitcnt lgkmcnt(0)
    v_mfma_f32_32x32x16_bf16 v[100:115], v[52:55], v[240:243], v[100:115]
    v_mul_f32 v122, v122, v98
    v_mul_f32 v123, v123, v99
    v_cvt_pk_bf16_f32 v84, v116, v117
    v_cvt_pk_bf16_f32 v85, v118, v119
    v_cvt_pk_bf16_f32 v86, v120, v121
    v_cvt_pk_bf16_f32 v87, v122, v123
    buffer_store_dwordx4 v[84:87], v16, s[56:59], s31 offen sc1
    s_waitcnt vmcnt(8)
    s_nop 3
    v_pk_mul_f32 v[116:117], v[100:101], v[100:101]
    v_pk_mul_f32 v[118:119], v[102:103], v[102:103]
    v_pk_mul_f32 v[120:121], v[104:105], v[104:105]
    v_pk_mul_f32 v[122:123], v[106:107], v[106:107]
    v_pk_fma_f32 v[116:117], v[116:117], s[60:61], v[10:11] op_sel_hi:[1,0,0]
    v_pk_fma_f32 v[118:119], v[118:119], s[60:61], v[10:11] op_sel_hi:[1,0,0]
    v_pk_fma_f32 v[120:121], v[120:121], s[60:61], v[10:11] op_sel_hi:[1,0,0]
    v_pk_fma_f32 v[122:123], v[122:123], s[60:61], v[10:11] op_sel_hi:[1,0,0]
    v_pk_mul_f32 v[116:117], v[116:117], v[100:101]
    v_pk_mul_f32 v[118:119], v[118:119], v[102:103]
    v_pk_mul_f32 v[120:121], v[120:121], v[104:105]
    v_pk_mul_f32 v[122:123], v[122:123], v[106:107]
    v_exp_f32 v116, v116
    v_pk_mul_f32 v[108:109], v[108:109], v[100:101]
    v_exp_f32 v117, v117
    v_pk_mul_f32 v[110:111], v[110:111], v[102:103]
    v_exp_f32 v118, v118
    v_pk_mul_f32 v[112:113], v[112:113], v[104:105]
    v_exp_f32 v119, v119
    v_pk_mul_f32 v[114:115], v[114:115], v[106:107]
    v_exp_f32 v120, v120
    v_exp_f32 v121, v121
    v_exp_f32 v122, v122
    v_exp_f32 v123, v123
    v_pk_add_f32 v[116:117], v[116:117], 1.0 op_sel_hi:[1,0]
    v_pk_add_f32 v[118:119], v[118:119], 1.0 op_sel_hi:[1,0]
    v_pk_add_f32 v[120:121], v[120:121], 1.0 op_sel_hi:[1,0]
    v_pk_add_f32 v[122:123], v[122:123], 1.0 op_sel_hi:[1,0]
    v_rcp_f32 v116, v116
    v_rcp_f32 v117, v117
    v_rcp_f32 v118, v118
    v_rcp_f32 v119, v119
    v_rcp_f32 v120, v120
    v_rcp_f32 v121, v121
    v_rcp_f32 v122, v122
    v_rcp_f32 v123, v123
    s_mov_b32 s31, 131072
    v_pk_mul_f32 v[116:117], v[116:117], v[108:109]
    v_pk_mul_f32 v[118:119], v[118:119], v[110:111]
    v_pk_mul_f32 v[120:121], v[120:121], v[112:113]
    v_pk_mul_f32 v[122:123], v[122:123], v[114:115]
    v_cvt_pk_bf16_f32 v100, v116, v117
    v_cvt_pk_bf16_f32 v101, v118, v119
    v_cvt_pk_bf16_f32 v102, v120, v121
    v_cvt_pk_bf16_f32 v103, v122, v123
    buffer_store_dwordx4 v[100:103], v16, s[56:59], s31 offen sc1
L_dskip:
    s_setprio 0
    s_barrier
    s_lshl_b32 s60, s2, 3
    s_add_u32 s60, s60, s12
    s_lshl_b32 s60, s60, 7
    s_add_u32 s60, s60, 15728640
    s_waitcnt vmcnt(0)
    v_mov_b32 v10, s3
    v_lshlrev_b32 v11, 25, v1
    buffer_store_dword v10, v11, s[4:7], s60 offen sc1
    s_add_u32 m0, s29, 0
    s_add_u32 s18, s18, 16384
    s_cmp_eq_u32 s18, 360448
    s_cselect_b32 s18, 0, s18
    buffer_load_dwordx4 v14, s[48:51], s18 offen lds
    s_add_u32 m0, s29, 2048
    s_add_u32 s18, s18, 16384
    s_cmp_eq_u32 s18, 360448
    s_cselect_b32 s18, 0, s18
    buffer_load_dwordx4 v14, s[48:51], s18 offen lds
    s_add_u32 m0, s29, 4096
    s_add_u32 s18, s18, 16384
    s_cmp_eq_u32 s18, 360448
    s_cselect_b32 s18, 0, s18
    buffer_load_dwordx4 v14, s[48:51], s18 offen lds
    s_add_u32 m0, s29, 12288
    s_add_u32 s18, s18, 16384
    s_cmp_eq_u32 s18, 360448
    s_cselect_b32 s18, 0, s18
    buffer_load_dwordx4 v14, s[48:51], s18 offen lds
    s_add_u32 m0, s29, 14336
    s_add_u32 s18, s18, 16384
    s_cmp_eq_u32 s18, 360448
    s_cselect_b32 s18, 0, s18
    buffer_load_dwordx4 v14, s[48:51], s18 offen lds
    s_add_u32 m0, s29, 16384
    s_add_u32 s18, s18, 16384
    s_cmp_eq_u32 s18, 360448
    s_cselect_b32 s18, 0, s18
    buffer_load_dwordx4 v14, s[48:51], s18 offen lds
    s_add_u32 m0, s29, 24576
    s_add_u32 s18, s18, 16384
    s_cmp_eq_u32 s18, 360448
    s_cselect_b32 s18, 0, s18
    buffer_load_dwordx4 v14, s[48:51], s18 offen lds
    s_add_u32 m0, s29, 26624
    s_add_u32 s18, s18, 16384
    s_cmp_eq_u32 s18, 360448
    s_cselect_b32 s18, 0, s18
    buffer_load_dwordx4 v14, s[48:51], s18 offen lds
    s_add_u32 m0, s29, 28672
    s_add_u32 s18, s18, 16384
    s_cmp_eq_u32 s18, 360448
    s_cselect_b32 s18, 0, s18
    buffer_load_dwordx4 v14, s[48:51], s18 offen lds
    s_add_u32 m0, s29, 36864
    s_add_u32 s18, s18, 16384
    s_cmp_eq_u32 s18, 360448
    s_cselect_b32 s18, 0, s18
    buffer_load_dwordx4 v14, s[48:51], s18 offen lds
    s_add_u32 m0, s29, 38912
    s_add_u32 s18, s18, 16384
    s_cmp_eq_u32 s18, 360448
    s_cselect_b32 s18, 0, s18
    buffer_load_dwordx4 v14, s[48:51], s18 offen lds
    s_add_u32 m0, s29, 40960
    s_add_u32 s18, s18, 16384
    s_cmp_eq_u32 s18, 360448
    s_cselect_b32 s18, 0, s18
    buffer_load_dwordx4 v14, s[48:51], s18 offen lds
    buffer_load_dword v7, v6, s[4:7], 0 offen sc1
    v_add_u32 v20, s19, v4
    v_xor_b32 v21, 64, v20
    ds_read_b64_tr_b16 v[36:37], v20 offset:0
    ds_read_b64_tr_b16 v[38:39], v20 offset:1024
    ds_read_b64_tr_b16 v[40:41], v21 offset:0
    ds_read_b64_tr_b16 v[42:43], v21 offset:1024
    ds_read_b64_tr_b16 v[44:45], v20 offset:2048
    ds_read_b64_tr_b16 v[46:47], v20 offset:3072
    ds_read_b64_tr_b16 v[48:49], v21 offset:2048
    ds_read_b64_tr_b16 v[50:51], v21 offset:3072
    s_waitcnt vmcnt(0) lgkmcnt(0)
    v_cmp_ne_u32 vcc, s3, v7
    s_cbranch_vccnz L_fc_o
L_fc_b:
    s_barrier
    buffer_load_dwordx4 v[124:127], v22, s[56:59], s32 offen sc1
    s_add_u32 s32, s32, 65536
    s_cmp_eq_u32 s32, 1441792
    s_cselect_b32 s32, 0, s32
    buffer_load_dwordx4 v[128:131], v22, s[56:59], s32 offen sc1
    s_add_u32 s32, s32, 65536
    s_cmp_eq_u32 s32, 1441792
    s_cselect_b32 s32, 0, s32
    buffer_load_dwordx4 v[132:135], v22, s[56:59], s32 offen sc1
    s_add_u32 s32, s32, 65536
    s_cmp_eq_u32 s32, 1441792
    s_cselect_b32 s32, 0, s32
    buffer_load_dwordx4 v[136:139], v22, s[56:59], s32 offen sc1
    s_add_u32 s32, s32, 65536
    s_cmp_eq_u32 s32, 1441792
    s_cselect_b32 s32, 0, s32
    buffer_load_dwordx4 v[140:143], v22, s[56:59], s32 offen sc1
    s_waitcnt vmcnt(4)
    s_waitcnt lgkmcnt(6)
    v_mfma_f32_32x32x16_bf16 v[68:83], v[36:39], v[124:127], 0
    ds_read_b64_tr_b16 v[52:53], v20 offset:4096
    ds_read_b64_tr_b16 v[54:55], v20 offset:5120
    s_add_u32 m0, s28, 0
    s_add_u32 s18, s18, 16384
    s_cmp_eq_u32 s18, 360448
    s_cselect_b32 s18, 0, s18
    buffer_load_dwordx4 v14, s[48:51], s18 offen lds
    s_add_u32 s32, s32, 65536
    s_cmp_eq_u32 s32, 1441792
    s_cselect_b32 s32, 0, s32
    buffer_load_dwordx4 v[144:147], v22, s[56:59], s32 offen sc1
    s_waitcnt lgkmcnt(6)
    v_mfma_f32_32x32x16_bf16 v[84:99], v[40:43], v[124:127], 0
    ds_read_b64_tr_b16 v[56:57], v21 offset:4096
    ds_read_b64_tr_b16 v[58:59], v21 offset:5120
    s_waitcnt vmcnt(5)
    s_waitcnt lgkmcnt(6)
    v_mfma_f32_32x32x16_bf16 v[68:83], v[44:47], v[128:131], v[68:83]
    ds_read_b64_tr_b16 v[36:37], v20 offset:6144
    ds_read_b64_tr_b16 v[38:39], v20 offset:7168
    s_add_u32 m0, s28, 2048
    s_add_u32 s18, s18, 16384
    s_cmp_eq_u32 s18, 360448
    s_cselect_b32 s18, 0, s18
    buffer_load_dwordx4 v14, s[48:51], s18 offen lds
    s_add_u32 s32, s32, 65536
    s_cmp_eq_u32 s32, 1441792
    s_cselect_b32 s32, 0, s32
    buffer_load_dwordx4 v[148:151], v22, s[56:59], s32 offen sc1
    s_waitcnt lgkmcnt(6)
    v_mfma_f32_32x32x16_bf16 v[84:99], v[48:51], v[128:131], v[84:99]
    ds_read_b64_tr_b16 v[40:41], v21 offset:6144
    ds_read_b64_tr_b16 v[42:43], v21 offset:7168
    s_waitcnt vmcnt(6)
    s_waitcnt lgkmcnt(6)
    v_mfma_f32_32x32x16_bf16 v[68:83], v[52:55], v[132:135], v[68:83]
    ds_read_b64_tr_b16 v[44:45], v20 offset:8192
    ds_read_b64_tr_b16 v[46:47], v20 offset:9216
    s_add_u32 s32, s32, 65536
    s_cmp_eq_u32 s32, 1441792
    s_cselect_b32 s32, 0, s32
    buffer_load_dwordx4 v[152:155], v22, s[56:59], s32 offen sc1
    s_add_u32 s32, s32, 65536
    s_cmp_eq_u32 s32, 1441792
    s_cselect_b32 s32, 0, s32
    buffer_load_dwordx4 v[156:159], v22, s[56:59], s32 offen sc1
    s_waitcnt lgkmcnt(6)
    v_mfma_f32_32x32x16_bf16 v[84:99], v[56:59], v[132:135], v[84:99]
    ds_read_b64_tr_b16 v[48:49], v21 offset:8192
    ds_read_b64_tr_b16 v[50:51], v21 offset:9216
    s_waitcnt vmcnt(7)
    s_waitcnt lgkmcnt(6)
    v_mfma_f32_32x32x16_bf16 v[68:83], v[36:39], v[136:139], v[68:83]
    ds_read_b64_tr_b16 v[52:53], v20 offset:10240
    ds_read_b64_tr_b16 v[54:55], v20 offset:11264
    s_add_u32 s32, s32, 65536
    s_cmp_eq_u32 s32, 1441792
    s_cselect_b32 s32, 0, s32
    buffer_load_dwordx4 v[160:163], v22, s[56:59], s32 offen sc1
    s_add_u32 s32, s32, 65536
    s_cmp_eq_u32 s32, 1441792
    s_cselect_b32 s32, 0, s32
    buffer_load_dwordx4 v[164:167], v22, s[56:59], s32 offen sc1
    s_waitcnt lgkmcnt(6)
    v_mfma_f32_32x32x16_bf16 v[84:99], v[40:43], v[136:139], v[84:99]
    ds_read_b64_tr_b16 v[56:57], v21 offset:10240
    ds_read_b64_tr_b16 v[58:59], v21 offset:11264
    s_waitcnt vmcnt(8)
    s_waitcnt lgkmcnt(6)
    v_mfma_f32_32x32x16_bf16 v[68:83], v[44:47], v[140:143], v[68:83]
    ds_read_b64_tr_b16 v[36:37], v20 offset:12288
    ds_read_b64_tr_b16 v[38:39], v20 offset:13312
    s_add_u32 s32, s32, 65536
    s_cmp_eq_u32 s32, 1441792
    s_cselect_b32 s32, 0, s32
    buffer_load_dwordx4 v[168:171], v22, s[56:59], s32 offen sc1
    s_waitcnt lgkmcnt(6)
    v_mfma_f32_32x32x16_bf16 v[84:99], v[48:51], v[140:143], v[84:99]
    ds_read_b64_tr_b16 v[40:41], v21 offset:12288
    ds_read_b64_tr_b16 v[42:43], v21 offset:13312
    s_waitcnt vmcnt(7)
    s_waitcnt lgkmcnt(6)
    v_mfma_f32_32x32x16_bf16 v[68:83], v[52:55], v[144:147], v[68:83]
    ds_read_b64_tr_b16 v[44:45], v20 offset:14336
    ds_read_b64_tr_b16 v[46:47], v20 offset:15360
    buffer_load_dword v7, v17, s[4:7], 0 offen sc1
    s_waitcnt lgkmcnt(6)
    v_mfma_f32_32x32x16_bf16 v[84:99], v[56:59], v[144:147], v[84:99]
    ds_read_b64_tr_b16 v[48:49], v21 offset:14336
    ds_read_b64_tr_b16 v[50:51], v21 offset:15360
    s_waitcnt vmcnt(6)
    s_waitcnt lgkmcnt(6)
    v_mfma_f32_32x32x16_bf16 v[68:83], v[36:39], v[148:151], v[68:83]
    v_add_u32 v20, s20, v4
    v_xor_b32 v21, 64, v20
    ds_read_b64_tr_b16 v[52:53], v20 offset:0
    ds_read_b64_tr_b16 v[54:55], v20 offset:1024
    s_add_u32 s32, s32, 65536
    s_cmp_eq_u32 s32, 1441792
    s_cselect_b32 s32, 0, s32
    buffer_load_dwordx4 v[172:175], v22, s[56:59], s32 offen sc1
    s_waitcnt lgkmcnt(6)
    v_mfma_f32_32x32x16_bf16 v[84:99], v[40:43], v[148:151], v[84:99]
    ds_read_b64_tr_b16 v[56:57], v21 offset:0
    ds_read_b64_tr_b16 v[58:59], v21 offset:1024
    s_waitcnt vmcnt(6)
    s_waitcnt lgkmcnt(6)
    v_mfma_f32_32x32x16_bf16 v[68:83], v[44:47], v[152:155], v[68:83]
    ds_read_b64_tr_b16 v[36:37], v20 offset:2048
    ds_read_b64_tr_b16 v[38:39], v20 offset:3072
    s_add_u32 s32, s32, 65536
    s_cmp_eq_u32 s32, 1441792
    s_cselect_b32 s32, 0, s32
    buffer_load_dwordx4 v[176:179], v22, s[56:59], s32 offen sc1
    s_waitcnt lgkmcnt(6)
    v_mfma_f32_32x32x16_bf16 v[84:99], v[48:51], v[152:155], v[84:99]
    ds_read_b64_tr_b16 v[40:41], v21 offset:2048
    ds_read_b64_tr_b16 v[42:43], v21 offset:3072
    s_waitcnt vmcnt(6)
    s_waitcnt lgkmcnt(6)
    v_mfma_f32_32x32x16_bf16 v[68:83], v[52:55], v[156:159], v[68:83]
    ds_read_b64_tr_b16 v[44:45], v20 offset:4096
    ds_read_b64_tr_b16 v[46:47], v20 offset:5120
    s_add_u32 s32, s32, 65536
    s_cmp_eq_u32 s32, 1441792
    s_cselect_b32 s32, 0, s32
    buffer_load_dwordx4 v[180:183], v22, s[56:59], s32 offen sc1
    s_waitcnt lgkmcnt(6)
    v_mfma_f32_32x32x16_bf16 v[84:99], v[56:59], v[156:159], v[84:99]
    ds_read_b64_tr_b16 v[48:49], v21 offset:4096
    ds_read_b64_tr_b16 v[50:51], v21 offset:5120
    s_waitcnt vmcnt(6)
    s_waitcnt lgkmcnt(6)
    v_mfma_f32_32x32x16_bf16 v[68:83], v[36:39], v[160:163], v[68:83]
    ds_read_b64_tr_b16 v[52:53], v20 offset:12288
    ds_read_b64_tr_b16 v[54:55], v20 offset:13312
    s_add_u32 s32, s32, 65536
    s_cmp_eq_u32 s32, 1441792
    s_cselect_b32 s32, 0, s32
    buffer_load_dwordx4 v[184:187], v22, s[56:59], s32 offen sc1
    s_waitcnt lgkmcnt(6)
    v_mfma_f32_32x32x16_bf16 v[84:99], v[40:43], v[160:163], v[84:99]
    ds_read_b64_tr_b16 v[56:57], v21 offset:12288
    ds_read_b64_tr_b16 v[58:59], v21 offset:13312
    s_waitcnt vmcnt(6)
    s_barrier
    s_waitcnt lgkmcnt(6)
    v_mfma_f32_32x32x16_bf16 v[68:83], v[44:47], v[164:167], v[68:83]
    ds_read_b64_tr_b16 v[36:37], v20 offset:14336
    ds_read_b64_tr_b16 v[38:39], v20 offset:15360
    s_add_u32 s32, s32, 65536
    s_cmp_eq_u32 s32, 1441792
    s_cselect_b32 s32, 0, s32
    buffer_load_dwordx4 v[188:191], v22, s[56:59], s32 offen sc1
    s_waitcnt lgkmcnt(6)
    v_mfma_f32_32x32x16_bf16 v[84:99], v[48:51], v[164:167], v[84:99]
    ds_read_b64_tr_b16 v[40:41], v21 offset:14336
    ds_read_b64_tr_b16 v[42:43], v21 offset:15360
    s_waitcnt vmcnt(6)
    s_waitcnt lgkmcnt(6)
    v_mfma_f32_32x32x16_bf16 v[68:83], v[52:55], v[168:171], v[68:83]
    ds_read_b64_tr_b16 v[44:45], v20 offset:16384
    ds_read_b64_tr_b16 v[46:47], v20 offset:17408
    s_add_u32 s32, s32, 65536
    s_cmp_eq_u32 s32, 1441792
    s_cselect_b32 s32, 0, s32
    buffer_load_dwordx4 v[192:195], v22, s[56:59], s32 offen sc1
    s_waitcnt lgkmcnt(6)
    v_mfma_f32_32x32x16_bf16 v[84:99], v[56:59], v[168:171], v[84:99]
    ds_read_b64_tr_b16 v[48:49], v21 offset:16384
    ds_read_b64_tr_b16 v[50:51], v21 offset:17408
    s_waitcnt vmcnt(5)
    s_waitcnt lgkmcnt(6)
    v_mfma_f32_32x32x16_bf16 v[68:83], v[36:39], v[172:175], v[68:83]
    ds_read_b64_tr_b16 v[52:53], v20 offset:24576
    ds_read_b64_tr_b16 v[54:55], v20 offset:25600
    s_add_u32 s32, s32, 65536
    s_cmp_eq_u32 s32, 1441792
    s_cselect_b32 s32, 0, s32
    buffer_load_dwordx4 v[196:199], v22, s[56:59], s32 offen sc1
    s_waitcnt lgkmcnt(6)
    v_mfma_f32_32x32x16_bf16 v[84:99], v[40:43], v[172:175], v[84:99]
    ds_read_b64_tr_b16 v[56:57], v21 offset:24576
    ds_read_b64_tr_b16 v[58:59], v21 offset:25600
    s_and_b32 s60, s12, 3
    s_xor_b32 s60, s60, 0
    s_lshl_b32 s60, s60, 14
    v_add_u32 v24, s60, v5
    s_waitcnt vmcnt(5)
    s_waitcnt lgkmcnt(6)
    v_mfma_f32_32x32x16_bf16 v[68:83], v[44:47], v[176:179], v[68:83]
    ds_read_b64_tr_b16 v[36:37], v20 offset:26624
    ds_read_b64_tr_b16 v[38:39], v20 offset:27648
    s_add_u32 s32, s32, 65536
    s_cmp_eq_u32 s32, 1441792
    s_cselect_b32 s32, 0, s32
    buffer_load_dwordx4 v[200:203], v22, s[56:59], s32 offen sc1
    s_waitcnt lgkmcnt(6)
    v_mfma_f32_32x32x16_bf16 v[84:99], v[48:51], v[176:179], v[84:99]
    ds_read_b64_tr_b16 v[40:41], v21 offset:26624
    ds_read_b64_tr_b16 v[42:43], v21 offset:27648
    s_and_b32 s60, s12, 3
    s_xor_b32 s60, s60, 1
    s_lshl_b32 s60, s60, 14
    v_add_u32 v25, s60, v5
    s_waitcnt vmcnt(5)
    s_waitcnt lgkmcnt(6)
    v_mfma_f32_32x32x16_bf16 v[68:83], v[52:55], v[180:183], v[68:83]
    ds_read_b64_tr_b16 v[44:45], v20 offset:28672
    ds_read_b64_tr_b16 v[46:47], v20 offset:29696
    s_add_u32 s32, s32, 65536
    s_cmp_eq_u32 s32, 1441792
    s_cselect_b32 s32, 0, s32
    buffer_load_dwordx4 v[204:207], v22, s[56:59], s32 offen sc1
    s_waitcnt lgkmcnt(6)
    v_mfma_f32_32x32x16_bf16 v[84:99], v[56:59], v[180:183], v[84:99]
    ds_read_b64_tr_b16 v[48:49], v21 offset:28672
    ds_read_b64_tr_b16 v[50:51], v21 offset:29696
    s_and_b32 s60, s12, 3
    s_xor_b32 s60, s60, 2
    s_lshl_b32 s60, s60, 14
    v_add_u32 v26, s60, v5
    s_waitcnt vmcnt(5)
    s_waitcnt lgkmcnt(6)
    v_mfma_f32_32x32x16_bf16 v[68:83], v[36:39], v[184:187], v[68:83]
    ds_read_b64_tr_b16 v[52:53], v20 offset:36864
    ds_read_b64_tr_b16 v[54:55], v20 offset:37888
    s_add_u32 s32, s32, 65536
    s_cmp_eq_u32 s32, 1441792
    s_cselect_b32 s32, 0, s32
    buffer_load_dwordx4 v[208:211], v22, s[56:59], s32 offen sc1
    s_waitcnt lgkmcnt(6)
    v_mfma_f32_32x32x16_bf16 v[84:99], v[40:43], v[184:187], v[84:99]
    ds_read_b64_tr_b16 v[56:57], v21 offset:36864
    ds_read_b64_tr_b16 v[58:59], v21 offset:37888
    s_and_b32 s60, s12, 3
    s_xor_b32 s60, s60, 3
    s_lshl_b32 s60, s60, 14
    v_add_u32 v27, s60, v5
    s_waitcnt vmcnt(5)
    s_waitcnt lgkmcnt(6)
    v_mfma_f32_32x32x16_bf16 v[68:83], v[44:47], v[188:191], v[68:83]
    ds_read_b64_tr_b16 v[36:37], v20 offset:38912
    ds_read_b64_tr_b16 v[38:39], v20 offset:39936
    v_cmp_ne_u32 vcc, s3, v7
    s_cbranch_vccnz L_fh_o
L_fh_b:
    buffer_load_dwordx4 v[32:35], v15, s[4:7], s27 offen sc1
    s_waitcnt lgkmcnt(6)
    v_mfma_f32_32x32x16_bf16 v[84:99], v[48:51], v[188:191], v[84:99]
    ds_read_b64_tr_b16 v[40:41], v21 offset:38912
    ds_read_b64_tr_b16 v[42:43], v21 offset:39936
    s_waitcnt vmcnt(5)
    s_waitcnt lgkmcnt(6)
    v_mfma_f32_32x32x16_bf16 v[68:83], v[52:55], v[192:195], v[68:83]
    ds_read_b64_tr_b16 v[44:45], v20 offset:40960
    ds_read_b64_tr_b16 v[46:47], v20 offset:41984
    s_waitcnt lgkmcnt(6)
    v_mfma_f32_32x32x16_bf16 v[84:99], v[56:59], v[192:195], v[84:99]
    ds_read_b64_tr_b16 v[48:49], v21 offset:40960
    ds_read_b64_tr_b16 v[50:51], v21 offset:41984
    s_waitcnt vmcnt(4)
    s_waitcnt lgkmcnt(6)
    v_mfma_f32_32x32x16_bf16 v[68:83], v[36:39], v[196:199], v[68:83]
    v_add_u32 v20, s19, v4
    v_xor_b32 v21, 64, v20
    ds_read_b64_tr_b16 v[52:53], v20 offset:0
    ds_read_b64_tr_b16 v[54:55], v20 offset:1024
    s_waitcnt lgkmcnt(6)
    v_mfma_f32_32x32x16_bf16 v[84:99], v[40:43], v[196:199], v[84:99]
    ds_read_b64_tr_b16 v[56:57], v21 offset:0
    ds_read_b64_tr_b16 v[58:59], v21 offset:1024
    s_waitcnt vmcnt(3)
    s_waitcnt lgkmcnt(6)
    v_mfma_f32_32x32x16_bf16 v[68:83], v[44:47], v[200:203], v[68:83]
    ds_read_b64_tr_b16 v[36:37], v20 offset:2048
    ds_read_b64_tr_b16 v[38:39], v20 offset:3072
    s_waitcnt lgkmcnt(6)
    v_mfma_f32_32x32x16_bf16 v[84:99], v[48:51], v[200:203], v[84:99]
    ds_read_b64_tr_b16 v[40:41], v21 offset:2048
    ds_read_b64_tr_b16 v[42:43], v21 offset:3072
    s_waitcnt vmcnt(2)
    s_waitcnt vmcnt(1)
    s_waitcnt lgkmcnt(0)
    v_mfma_f32_32x32x16_bf16 v[84:99], v[56:59], v[204:207], v[84:99]
    v_mfma_f32_32x32x16_bf16 v[84:99], v[40:43], v[208:211], v[84:99]
    v_mfma_f32_32x32x16_bf16 v[68:83], v[52:55], v[204:207], v[68:83]
    v_mfma_f32_32x32x16_bf16 v[68:83], v[36:39], v[208:211], v[68:83]
    s_waitcnt vmcnt(0)
    v_lshlrev_b32 v116, 16, v32
    v_and_b32 v117, 0xffff0000, v32
    v_lshlrev_b32 v118, 16, v33
    v_and_b32 v119, 0xffff0000, v33
    v_lshlrev_b32 v120, 16, v34
    v_and_b32 v121, 0xffff0000, v34
    v_lshlrev_b32 v122, 16, v35
    v_and_b32 v123, 0xffff0000, v35
    s_and_b32 s60, s12, 3
    s_lshl_b32 s61, s60, 1
    v_add_u32 v9, s61, v28
    v_xor_b32 v9, v9, v1
    v_and_b32 v9, 7, v9
    v_and_b32 v10, 31, v1
    v_lshlrev_b32 v10, 7, v10
    v_lshl_add_u32 v6, v9, 4, v10
    s_lshl_b32 s61, s24, 2
    v_add_u32 v6, s61, v6
    v_lshrrev_b32 v9, 3, v1
    v_lshlrev_b32 v10, 4, v9
    v_xor_b32 v22, v15, v10
    s_lshl_b32 s61, s12, 10
    v_add_u32 v22, s61, v22
    v_lshlrev_b32 v23, 18, v9
    v_and_b32 v9, 0x70, v15
    v_add_u32 v23, v23, v9
    s_mul_i32 s60, s60, 992
    s_add_u32 s25, s25, s60
    ds_write_b128 v26, v[84:87] offset:4096
    ds_write_b128 v26, v[88:91] offset:5120
    ds_write_b128 v27, v[92:95] offset:8192
    ds_write_b128 v27, v[96:99] offset:9216
    ds_write_b128 v25, v[76:79] offset:0
    ds_write_b128 v25, v[80:83] offset:1024
    s_waitcnt lgkmcnt(0)
    s_barrier
    ds_read_b128 v[140:143], v24 offset:0
    ds_read_b128 v[144:147], v24 offset:1024
    ds_read_b128 v[148:151], v24 offset:4096
    ds_read_b128 v[152:155], v24 offset:5120
    ds_read_b128 v[156:159], v24 offset:8192
    ds_read_b128 v[160:163], v24 offset:9216
    s_waitcnt lgkmcnt(4)
    v_pk_add_f32 v[68:69], v[68:69], v[140:141]
    v_pk_add_f32 v[70:71], v[70:71], v[142:143]
    v_pk_add_f32 v[72:73], v[72:73], v[144:145]
    v_pk_add_f32 v[74:75], v[74:75], v[146:147]
    s_waitcnt lgkmcnt(2)
    v_pk_add_f32 v[68:69], v[68:69], v[148:149]
    v_pk_add_f32 v[70:71], v[70:71], v[150:151]
    v_pk_add_f32 v[72:73], v[72:73], v[152:153]
    v_pk_add_f32 v[74:75], v[74:75], v[154:155]
    s_waitcnt lgkmcnt(0)
    v_pk_add_f32 v[68:69], v[68:69], v[156:157]
    v_pk_add_f32 v[70:71], v[70:71], v[158:159]
    v_pk_add_f32 v[72:73], v[72:73], v[160:161]
    v_pk_add_f32 v[74:75], v[74:75], v[162:163]
    v_cvt_pk_bf16_f32 v140, v68, v69
    v_cvt_pk_bf16_f32 v141, v70, v71
    v_cvt_pk_bf16_f32 v142, v72, v73
    v_cvt_pk_bf16_f32 v143, v74, v75
    v_lshlrev_b32 v68, 16, v140
    v_and_b32 v69, 0xffff0000, v140
    v_lshlrev_b32 v70, 16, v141
    v_and_b32 v71, 0xffff0000, v141
    v_lshlrev_b32 v72, 16, v142
    v_and_b32 v73, 0xffff0000, v142
    v_lshlrev_b32 v74, 16, v143
    v_and_b32 v75, 0xffff0000, v143
    v_pk_add_f32 v[68:69], v[68:69], v[116:117]
    v_pk_add_f32 v[70:71], v[70:71], v[118:119]
    v_pk_add_f32 v[72:73], v[72:73], v[120:121]
    v_pk_add_f32 v[74:75], v[74:75], v[122:123]
    v_cvt_pk_bf16_f32 v140, v68, v69
    v_cvt_pk_bf16_f32 v141, v70, v71
    v_cvt_pk_bf16_f32 v142, v72, v73
    v_cvt_pk_bf16_f32 v143, v74, v75
    ds_write_b128 v6, v[140:143]
    s_waitcnt lgkmcnt(0)
    s_barrier
    ds_read_b128 v[140:143], v22
    s_waitcnt lgkmcnt(0)
    buffer_store_dwordx4 v[140:143], v23, s[52:55], s25 offen sc1
L_end:
    s_endpgm
Lpu_r:
    s_mov_b32 s35, 0
Lpu_r2:
    s_mov_b64 exec, vcc
    s_sleep 2
    buffer_load_dwordx4 v[76:79], v84, s[4:7], s23 offen sc1
    buffer_load_dwordx4 v[80:83], v84, s[4:7], s25 offen sc1
    s_waitcnt vmcnt(0)
    v_cmp_ne_u32 vcc, s3, v78
    v_cmp_ne_u32 s[62:63], s3, v82
    s_nop 0
    s_or_b64 vcc, vcc, s[62:63]
    s_add_u32 s35, s35, 1
    s_cmp_gt_u32 s35, 200000
    s_cbranch_scc1 Lpu_x
    s_cbranch_vccnz Lpu_r2
Lpu_x:
    s_mov_b64 exec, -1
    s_branch Lpu_ok
Lpv_r:
    s_mov_b32 s35, 0
Lpv_r2:
    s_mov_b64 exec, vcc
    s_sleep 2
    buffer_load_dwordx4 v[88:91], v144, s[4:7], s23 offen sc1
    buffer_load_dwordx4 v[92:95], v144, s[4:7], s25 offen sc1
    s_waitcnt vmcnt(0)
    v_cmp_ne_u32 vcc, s3, v90
    v_cmp_ne_u32 s[62:63], s3, v94
    s_nop 0
    s_or_b64 vcc, vcc, s[62:63]
    s_add_u32 s35, s35, 1
    s_cmp_gt_u32 s35, 200000
    s_cbranch_scc1 Lpv_x
    s_cbranch_vccnz Lpv_r2
Lpv_x:
    s_mov_b64 exec, -1
    s_branch Lpv_ok
Lpa0_r:
    s_mov_b32 s35, 0
Lpa0_r2:
    s_mov_b64 exec, vcc
    s_sleep 2
    s_add_u32 s33, s21, 0
    buffer_load_dwordx4 v[116:119], v15, s[4:7], s33 offen offset:0 sc1
    buffer_load_dwordx4 v[120:123], v15, s[4:7], s33 offen offset:1024 sc1
    buffer_load_dwordx4 v[124:127], v15, s[4:7], s33 offen offset:2048 sc1
    buffer_load_dwordx4 v[128:131], v15, s[4:7], s33 offen offset:3072 sc1
    s_waitcnt vmcnt(0)
    v_max3_u32 v8, v116, v117, v118
    v_max_u32 v8, v8, v119
    v_cmp_eq_u32 vcc, -1, v8
    s_add_u32 s35, s35, 1
    s_cmp_gt_u32 s35, 200000
    s_cbranch_scc1 Lpa0_x
    s_cbranch_vccnz Lpa0_r2
Lpa0_x:
    s_mov_b64 exec, -1
    s_branch Lpa0_ok
Lpa1_r:
    s_mov_b32 s35, 0
Lpa1_r2:
    s_mov_b64 exec, vcc
    s_sleep 2
    s_add_u32 s33, s21, 0
    buffer_load_dwordx4 v[120:123], v15, s[4:7], s33 offen offset:1024 sc1
    buffer_load_dwordx4 v[124:127], v15, s[4:7], s33 offen offset:2048 sc1
    buffer_load_dwordx4 v[128:131], v15, s[4:7], s33 offen offset:3072 sc1
    s_waitcnt vmcnt(0)
    v_max3_u32 v8, v120, v121, v122
    v_max_u32 v8, v8, v123
    v_cmp_eq_u32 vcc, -1, v8
    s_add_u32 s35, s35, 1
    s_cmp_gt_u32 s35, 200000
    s_cbranch_scc1 Lpa1_x
    s_cbranch_vccnz Lpa1_r2
Lpa1_x:
    s_mov_b64 exec, -1
    s_branch Lpa1_ok
Lpa2_r:
    s_mov_b32 s35, 0
Lpa2_r2:
    s_mov_b64 exec, vcc
    s_sleep 2
    s_add_u32 s33, s21, 0
    buffer_load_dwordx4 v[124:127], v15, s[4:7], s33 offen offset:2048 sc1
    buffer_load_dwordx4 v[128:131], v15, s[4:7], s33 offen offset:3072 sc1
    s_waitcnt vmcnt(0)
    v_max3_u32 v8, v124, v125, v126
    v_max_u32 v8, v8, v127
    v_cmp_eq_u32 vcc, -1, v8
    s_add_u32 s35, s35, 1
    s_cmp_gt_u32 s35, 200000
    s_cbranch_scc1 Lpa2_x
    s_cbranch_vccnz Lpa2_r2
Lpa2_x:
    s_mov_b64 exec, -1
    s_branch Lpa2_ok
Lpa3_r:
    s_mov_b32 s35, 0
Lpa3_r2:
    s_mov_b64 exec, vcc
    s_sleep 2
    s_add_u32 s33, s21, 0
    buffer_load_dwordx4 v[128:131], v15, s[4:7], s33 offen offset:3072 sc1
    s_waitcnt vmcnt(0)
    v_max3_u32 v8, v128, v129, v130
    v_max_u32 v8, v8, v131
    v_cmp_eq_u32 vcc, -1, v8
    s_add_u32 s35, s35, 1
    s_cmp_gt_u32 s35, 200000
    s_cbranch_scc1 Lpa3_x
    s_cbranch_vccnz Lpa3_r2
Lpa3_x:
    s_mov_b64 exec, -1
    s_branch Lpa3_ok
Lpa4_r:
    s_mov_b32 s35, 0
Lpa4_r2:
    s_mov_b64 exec, vcc
    s_sleep 2
    s_add_u32 s33, s21, 4096
    buffer_load_dwordx4 v[132:135], v15, s[4:7], s33 offen offset:0 sc1
    buffer_load_dwordx4 v[136:139], v15, s[4:7], s33 offen offset:1024 sc1
    buffer_load_dwordx4 v[140:143], v15, s[4:7], s33 offen offset:2048 sc1
    buffer_load_dwordx4 v[144:147], v15, s[4:7], s33 offen offset:3072 sc1
    s_waitcnt vmcnt(0)
    v_max3_u32 v8, v132, v133, v134
    v_max_u32 v8, v8, v135
    v_cmp_eq_u32 vcc, -1, v8
    s_add_u32 s35, s35, 1
    s_cmp_gt_u32 s35, 200000
    s_cbranch_scc1 Lpa4_x
    s_cbranch_vccnz Lpa4_r2
Lpa4_x:
    s_mov_b64 exec, -1
    s_branch Lpa4_ok
Lpa5_r:
    s_mov_b32 s35, 0
Lpa5_r2:
    s_mov_b64 exec, vcc
    s_sleep 2
    s_add_u32 s33, s21, 4096
    buffer_load_dwordx4 v[136:139], v15, s[4:7], s33 offen offset:1024 sc1
    buffer_load_dwordx4 v[140:143], v15, s[4:7], s33 offen offset:2048 sc1
    buffer_load_dwordx4 v[144:147], v15, s[4:7], s33 offen offset:3072 sc1
    s_waitcnt vmcnt(0)
    v_max3_u32 v8, v136, v137, v138
    v_max_u32 v8, v8, v139
    v_cmp_eq_u32 vcc, -1, v8
    s_add_u32 s35, s35, 1
    s_cmp_gt_u32 s35, 200000
    s_cbranch_scc1 Lpa5_x
    s_cbranch_vccnz Lpa5_r2
Lpa5_x:
    s_mov_b64 exec, -1
    s_branch Lpa5_ok
Lpa6_r:
    s_mov_b32 s35, 0
Lpa6_r2:
    s_mov_b64 exec, vcc
    s_sleep 2
    s_add_u32 s33, s21, 4096
    buffer_load_dwordx4 v[140:143], v15, s[4:7], s33 offen offset:2048 sc1
    buffer_load_dwordx4 v[144:147], v15, s[4:7], s33 offen offset:3072 sc1
    s_waitcnt vmcnt(0)
    v_max3_u32 v8, v140, v141, v142
    v_max_u32 v8, v8, v143
    v_cmp_eq_u32 vcc, -1, v8
    s_add_u32 s35, s35, 1
    s_cmp_gt_u32 s35, 200000
    s_cbranch_scc1 Lpa6_x
    s_cbranch_vccnz Lpa6_r2
Lpa6_x:
    s_mov_b64 exec, -1
    s_branch Lpa6_ok
Lpa7_r:
    s_mov_b32 s35, 0
Lpa7_r2:
    s_mov_b64 exec, vcc
    s_sleep 2
    s_add_u32 s33, s21, 4096
    buffer_load_dwordx4 v[144:147], v15, s[4:7], s33 offen offset:3072 sc1
    s_waitcnt vmcnt(0)
    v_max3_u32 v8, v144, v145, v146
    v_max_u32 v8, v8, v147
    v_cmp_eq_u32 vcc, -1, v8
    s_add_u32 s35, s35, 1
    s_cmp_gt_u32 s35, 200000
    s_cbranch_scc1 Lpa7_x
    s_cbranch_vccnz Lpa7_r2
Lpa7_x:
    s_mov_b64 exec, -1
    s_branch Lpa7_ok
L_nt_r:
    v_max3_u32 v8, v116, v117, v118
    v_max3_u32 v9, v119, v120, v121
    v_max3_u32 v8, v8, v122, v123
    v_max3_u32 v9, v9, v124, v125
    v_max3_u32 v8, v8, v126, v127
    v_max3_u32 v9, v9, v128, v129
    v_max3_u32 v8, v8, v130, v131
    v_max3_u32 v9, v9, v132, v133
    v_max3_u32 v8, v8, v134, v135
    v_max3_u32 v9, v9, v136, v137
    v_max3_u32 v8, v8, v138, v139
    v_max3_u32 v9, v9, v140, v141
    v_max3_u32 v8, v8, v142, v143
    v_max3_u32 v9, v9, v144, v145
    v_max3_u32 v8, v8, v146, v147
    v_max3_u32 v9, v9, v148, v149
    v_max3_u32 v8, v8, v150, v151
    v_max3_u32 v9, v9, v152, v153
    v_max3_u32 v8, v8, v154, v155
    v_max3_u32 v9, v9, v156, v157
    v_max3_u32 v8, v8, v158, v159
    v_max3_u32 v9, v9, v160, v161
    v_max3_u32 v8, v8, v162, v163
    v_max3_u32 v9, v9, v164, v165
    v_max3_u32 v8, v8, v166, v167
    v_max3_u32 v9, v9, v168, v169
    v_max3_u32 v8, v8, v170, v171
    v_max3_u32 v9, v9, v172, v173
    v_max3_u32 v8, v8, v174, v175
    v_max3_u32 v9, v9, v176, v177
    v_max3_u32 v8, v8, v178, v179
    v_max3_u32 v9, v9, v180, v181
    v_max3_u32 v8, v8, v182, v183
    v_max3_u32 v9, v9, v184, v185
    v_max3_u32 v8, v8, v186, v187
    v_max3_u32 v9, v9, v188, v189
    v_max3_u32 v8, v8, v190, v191
    v_max3_u32 v9, v9, v192, v193
    v_max3_u32 v8, v8, v194, v195
    v_max3_u32 v9, v9, v196, v197
    v_max3_u32 v8, v8, v198, v199
    v_max3_u32 v9, v9, v200, v201
    v_max3_u32 v8, v8, v202, v203
    v_max3_u32 v9, v9, v204, v205
    v_max3_u32 v8, v8, v206, v207
    v_max3_u32 v9, v9, v208, v209
    v_max3_u32 v8, v8, v210, v211
    v_max3_u32 v9, v9, v212, v213
    v_max3_u32 v8, v8, v214, v215
    v_max3_u32 v9, v9, v216, v217
    v_max3_u32 v8, v8, v218, v219
    v_max3_u32 v9, v9, v220, v221
    v_max3_u32 v8, v8, v222, v223
    v_max3_u32 v9, v9, v224, v225
    v_max3_u32 v8, v8, v226, v227
    v_max3_u32 v9, v9, v228, v229
    v_max3_u32 v8, v8, v230, v231
    v_max3_u32 v9, v9, v232, v233
    v_max3_u32 v8, v8, v234, v235
    v_max3_u32 v9, v9, v236, v237
    v_max3_u32 v8, v8, v238, v239
    v_max3_u32 v9, v9, v240, v241
    v_max3_u32 v8, v8, v242, v243
    v_max_u32 v8, v8, v9
    v_cmp_eq_u32 vcc, -1, v8
    s_cbranch_vccz L_nt_ok
    s_add_u32 s34, s34, 1
    s_cmp_gt_u32 s34, 2000
    s_cbranch_scc1 L_nt_ok
    s_waitcnt vmcnt(0) lgkmcnt(0)
    s_nop 15
    s_branch L_dredo
L_idle_o:
    s_lshl_b32 s60, s2, 3
    s_add_u32 s60, s60, s12
    s_cmp_eq_u32 s60, 2040
    s_mov_b32 s60, 14688256
    s_cselect_b32 s60, s60, 25165824
    v_mov_b32 v10, s3
    v_lshlrev_b32 v11, 25, v1
    buffer_store_dword v10, v11, s[4:7], s60 offen sc1
    s_add_u32 m0, s28, 0
    s_lshl_b32 s18, s26, 14
    buffer_load_dwordx4 v14, s[48:51], s18 offen lds
    s_add_u32 m0, s28, 2048
    s_add_u32 s18, s18, 16384
    s_cmp_eq_u32 s18, 360448
    s_cselect_b32 s18, 0, s18
    buffer_load_dwordx4 v14, s[48:51], s18 offen lds
    s_add_u32 m0, s28, 4096
    s_add_u32 s18, s18, 16384
    s_cmp_eq_u32 s18, 360448
    s_cselect_b32 s18, 0, s18
    buffer_load_dwordx4 v14, s[48:51], s18 offen lds
    s_add_u32 m0, s28, 6144
    s_add_u32 s18, s18, 16384
    s_cmp_eq_u32 s18, 360448
    s_cselect_b32 s18, 0, s18
    buffer_load_dwordx4 v14, s[48:51], s18 offen lds
    s_add_u32 m0, s28, 8192
    s_add_u32 s18, s18, 16384
    s_cmp_eq_u32 s18, 360448
    s_cselect_b32 s18, 0, s18
    buffer_load_dwordx4 v14, s[48:51], s18 offen lds
    s_add_u32 m0, s28, 10240
    s_add_u32 s18, s18, 16384
    s_cmp_eq_u32 s18, 360448
    s_cselect_b32 s18, 0, s18
    buffer_load_dwordx4 v14, s[48:51], s18 offen lds
    s_add_u32 m0, s28, 12288
    s_add_u32 s18, s18, 16384
    s_cmp_eq_u32 s18, 360448
    s_cselect_b32 s18, 0, s18
    buffer_load_dwordx4 v14, s[48:51], s18 offen lds
    s_add_u32 m0, s28, 14336
    s_add_u32 s18, s18, 16384
    s_cmp_eq_u32 s18, 360448
    s_cselect_b32 s18, 0, s18
    buffer_load_dwordx4 v14, s[48:51], s18 offen lds
    s_waitcnt vmcnt(0)
    s_branch L_dskip
L_fc_o:
    s_mov_b32 s63, 0
L_fc_r:
    s_mov_b64 exec, vcc
    s_sleep 2
    buffer_load_dword v7, v6, s[4:7], 0 offen sc1
    s_waitcnt vmcnt(0)
    v_cmp_ne_u32 vcc, s3, v7
    s_add_u32 s63, s63, 1
    s_cmp_gt_u32 s63, 200000
    s_cbranch_scc1 L_fc_x
    s_cbranch_vccnz L_fc_r
L_fc_x:
    s_mov_b64 exec, -1
    s_branch L_fc_b
L_fh_o:
    s_mov_b32 s63, 0
L_fh_r:
    s_mov_b64 exec, vcc
    s_sleep 2
    buffer_load_dword v7, v17, s[4:7], 0 offen sc1
    s_waitcnt vmcnt(0)
    v_cmp_ne_u32 vcc, s3, v7
    s_add_u32 s63, s63, 1
    s_cmp_gt_u32 s63, 200000
    s_cbranch_scc1 L_fh_x
    s_cbranch_vccnz L_fh_r
L_fh_x:
    s_mov_b64 exec, -1
    s_branch L_fh_b
L_codeend:

.section .rodata,"a"
.p2align 6
.amdhsa_kernel sequential_preLN__spectral_gfnet__glu_gated_geglu__prompt_kernel
  .amdhsa_next_free_vgpr 256
  .amdhsa_next_free_sgpr 102
  .amdhsa_accum_offset 256
  .amdhsa_group_segment_fixed_size 0
  .amdhsa_kernarg_size 80
  .amdhsa_user_sgpr_count 2
  .amdhsa_user_sgpr_kernarg_segment_ptr 1
  .amdhsa_system_sgpr_workgroup_id_x 1
.end_amdhsa_kernel
```
